```python
import torch

def _softmax(x, axis=-1):
    return torch.softmax(x, dim=axis)
def _gelu(x):
    return torch.nn.functional.gelu(x, approximate="tanh")
def _silu(x):
    return torch.nn.functional.silu(x)
def _sigmoid(x):
    return torch.sigmoid(x)
def _layernorm(x, axis=-1, eps=1e-5):
    m = x.mean(dim=axis, keepdim=True)
    v = x.var(dim=axis, keepdim=True, unbiased=False)
    return (x - m) / torch.sqrt(v + eps)
def _scatter_add(tgt, idx, src, axis=0):
    return tgt.clone().index_add_(axis, idx, src)
def _segment_sum(src, seg, n):
    out = torch.zeros((n,) + src.shape[1:], dtype=src.dtype)
    return out.index_add_(0, seg, src)
def _pad(x, pw):
    flat = tuple(v for pair in reversed(pw) for v in pair)
    return torch.nn.functional.pad(x, flat)

kernel_name = 'recurrent_scan__mha_block_cached__dense_activation_gelu__decode'

def setup_inputs():

    _w = (lambda a: (lambda t: t.to(torch.bfloat16) if t.is_floating_point() else t)(torch.as_tensor(a)))
    def _A_setup():
        B, Sq, D = 8, 1, 640
        H, Sk, Dh = 32, 4096, 128
        return {
            "x": _w((lambda *s: torch.randn(*s, dtype=torch.bfloat16) * 0.1)(B, Sq, D)),
            "k_cache": _w((lambda *s: torch.randn(*s, dtype=torch.bfloat16) * 0.8)(B, H, Sk, Dh)),
            "v_cache": _w((lambda *s: torch.randn(*s, dtype=torch.bfloat16) * 3.2)(B, H, Sk, Dh)),
            "wq": _w((lambda *s: torch.randn(*s, dtype=torch.bfloat16) * 0.8)(D, H * Dh) * (D ** -0.5)),
            "wo": _w((lambda *s: torch.randn(*s, dtype=torch.bfloat16) * 3.2)(H * Dh, D) * ((H * Dh) ** -0.5)),
        }
    _A_in = _A_setup()

    def _B_setup():
        B, S, D, F = 8, 1, 640, 1728
        return {
            "x": _w((lambda *s: torch.randn(*s, dtype=torch.bfloat16) * 0.1)(B, S, D)),
            "w1": _w((lambda *s: torch.randn(*s, dtype=torch.bfloat16) * 3.2)(D, F) * (D ** -0.5)),
            "b1": _w((lambda *s: torch.randn(*s, dtype=torch.bfloat16) * 3.2)(F) * 0.01),
            "w2": _w((lambda *s: torch.randn(*s, dtype=torch.bfloat16) * 3.2)(F, D) * (F ** -0.5)),
            "b2": _w((lambda *s: torch.randn(*s, dtype=torch.bfloat16) * 3.2)(D) * 0.01),
        }
    _B_in = _B_setup()

    return {
        "A_x": _A_in["x"],
        "A_k_cache": _A_in["k_cache"],
        "A_v_cache": _A_in["v_cache"],
        "A_wq": _A_in["wq"],
        "A_wo": _A_in["wo"],
        "B_x": _B_in["x"],
        "B_w1": _B_in["w1"],
        "B_b1": _B_in["b1"],
        "B_w2": _B_in["w2"],
        "B_b2": _B_in["b2"],
    }

def reference(A_x, A_k_cache, A_v_cache, A_wq, A_wo, B_x, B_w1, B_b1, B_w2, B_b2):
    def _A_ref(x, k_cache, v_cache, wq, wo):
        B, Sq, D = x.shape
        H, Dh = 32, 128
        q = (lambda x, *d: x.permute(*d))((x @ wq).reshape(B, Sq, H, Dh), 0, 2, 1, 3)
        scores = torch.einsum("bhqd,bhkd->bhqk", q, k_cache) * (Dh ** -0.5)
        p = _softmax(scores, axis=-1)
        o = torch.einsum("bhqk,bhkd->bhqd", p, v_cache)
        return (lambda x, *d: x.permute(*d))(o, 0, 2, 1, 3).reshape(B, Sq, H * Dh) @ wo

    def _B_ref(x, w1, b1, w2, b2):
        h = torch.einsum("bsd,df->bsf", x, w1) + b1
        h = _gelu(h)
        return torch.einsum("bsf,fd->bsd", h, w2) + b2

    x = A_x
    xn = _layernorm(x, axis=-1)
    s = _A_ref(xn, A_k_cache, A_v_cache, A_wq, A_wo)
    g = _silu(_B_ref(xn, B_w1, B_b1, B_w2, B_b2))
    return x + s * g
```

```asm
; @launch grid=(256,1,1) block=(1024,1,1) lds=163840
.amdgcn_target "amdgcn-amd-amdhsa--gfx950"
.text
.globl recurrent_scan__mha_block_cached__dense_activation_gelu__decode_kernel
.p2align 8
.type recurrent_scan__mha_block_cached__dense_activation_gelu__decode_kernel,@function
recurrent_scan__mha_block_cached__dense_activation_gelu__decode_kernel:
    s_cmp_ge_u32 s2, 256
    s_cbranch_scc1 L_end
    s_load_dwordx16 s[16:31], s[0:1], 0
    s_load_dwordx8 s[32:39], s[0:1], 64
    s_load_dwordx2 s[40:41], s[0:1], 96
    v_and_b32 v1, 63, v0
    v_lshrrev_b32 v2, 6, v0
    s_nop 0
    v_readfirstlane_b32 s3, v2
    v_lshrrev_b32 v2, 4, v1
    v_and_b32 v3, 15, v1
    s_lshr_b32 s4, s2, 5
    s_and_b32 s5, s2, 31
    s_lshl_b32 s15, s4, 5
    s_add_u32 s15, s15, s5
    v_and_b32 v36, 7, v3
    v_mov_b32 v37, 0xffff
    v_mov_b32 v38, 0xffff0000
    v_mov_b32 v4, 0
    v_cmp_eq_u32 vcc, 0, v3
    s_nop 1
    v_cndmask_b32 v4, v4, v37, vcc
    v_cmp_eq_u32 vcc, 1, v3
    s_nop 1
    v_cndmask_b32 v4, v4, v38, vcc
    v_mov_b32 v8, 0
    v_cmp_eq_u32 vcc, 0, v36
    s_nop 1
    v_cndmask_b32 v8, v8, v37, vcc
    v_cmp_eq_u32 vcc, 1, v36
    s_nop 1
    v_cndmask_b32 v8, v8, v38, vcc
    v_mov_b32 v5, 0
    v_cmp_eq_u32 vcc, 2, v3
    s_nop 1
    v_cndmask_b32 v5, v5, v37, vcc
    v_cmp_eq_u32 vcc, 3, v3
    s_nop 1
    v_cndmask_b32 v5, v5, v38, vcc
    v_mov_b32 v9, 0
    v_cmp_eq_u32 vcc, 2, v36
    s_nop 1
    v_cndmask_b32 v9, v9, v37, vcc
    v_cmp_eq_u32 vcc, 3, v36
    s_nop 1
    v_cndmask_b32 v9, v9, v38, vcc
    v_mov_b32 v6, 0
    v_cmp_eq_u32 vcc, 4, v3
    s_nop 1
    v_cndmask_b32 v6, v6, v37, vcc
    v_cmp_eq_u32 vcc, 5, v3
    s_nop 1
    v_cndmask_b32 v6, v6, v38, vcc
    v_mov_b32 v10, 0
    v_cmp_eq_u32 vcc, 4, v36
    s_nop 1
    v_cndmask_b32 v10, v10, v37, vcc
    v_cmp_eq_u32 vcc, 5, v36
    s_nop 1
    v_cndmask_b32 v10, v10, v38, vcc
    v_mov_b32 v7, 0
    v_cmp_eq_u32 vcc, 6, v3
    s_nop 1
    v_cndmask_b32 v7, v7, v37, vcc
    v_cmp_eq_u32 vcc, 7, v3
    s_nop 1
    v_cndmask_b32 v7, v7, v38, vcc
    v_mov_b32 v11, 0
    v_cmp_eq_u32 vcc, 6, v36
    s_nop 1
    v_cndmask_b32 v11, v11, v37, vcc
    v_cmp_eq_u32 vcc, 7, v36
    s_nop 1
    v_cndmask_b32 v11, v11, v38, vcc
    s_waitcnt lgkmcnt(0)
    s_lshl_b32 s8, s15, 20
    s_add_u32 s10, s18, s8
    s_addc_u32 s11, s19, 0
    s_mov_b32 s44, s10
    s_and_b32 s45, s11, 0xffff
    s_mov_b32 s46, 1048576
    s_mov_b32 s47, 0x00020000
    s_add_u32 s10, s20, s8
    s_addc_u32 s11, s21, 0
    s_mov_b32 s48, s10
    s_and_b32 s49, s11, 0xffff
    s_mov_b32 s50, 1048576
    s_mov_b32 s51, 0x00020000
    s_mov_b32 s52, s16
    s_and_b32 s53, s17, 0xffff
    s_mov_b32 s54, 10240
    s_mov_b32 s55, 0x00020000
    s_lshl_b32 s8, s5, 8
    s_add_u32 s10, s22, s8
    s_addc_u32 s11, s23, 0
    s_mov_b32 s56, s10
    s_and_b32 s57, s11, 0xffff
    s_mov_b32 s58, 0
    s_mov_b32 s59, 0x00020000
    s_sub_u32 s58, 5242880, s8
    s_mul_i32 s8, s5, 163840
    s_add_u32 s10, s24, s8
    s_addc_u32 s11, s25, 0
    s_mov_b32 s60, s10
    s_and_b32 s61, s11, 0xffff
    s_mov_b32 s62, 163840
    s_mov_b32 s63, 0x00020000
    s_and_b32 s8, s3, 7
    s_mul_i32 s8, s8, 1280
    v_lshlrev_b32 v36, 4, v1
    v_lshlrev_b32 v37, 2, v1
    buffer_load_dwordx4 v[40:43], v36, s[52:55], s8 offen
    buffer_load_dword v44, v37, s[52:55], s8 offen offset:1024
    s_mul_i32 s8, s3, 40
    v_add_u32 v38, s8, v2
    v_lshlrev_b32 v38, 13, v38
    v_lshl_add_u32 v38, v3, 4, v38
    s_mov_b32 s6, 0
    buffer_load_dwordx4 v[80:83], v38, s[56:59], s6 offen
    s_mov_b32 s6, 32768
    buffer_load_dwordx4 v[84:87], v38, s[56:59], s6 offen
    s_mov_b32 s6, 65536
    buffer_load_dwordx4 v[88:91], v38, s[56:59], s6 offen
    s_mov_b32 s6, 98304
    buffer_load_dwordx4 v[92:95], v38, s[56:59], s6 offen
    s_mov_b32 s6, 131072
    buffer_load_dwordx4 v[96:99], v38, s[56:59], s6 offen
    s_mov_b32 s6, 163840
    buffer_load_dwordx4 v[100:103], v38, s[56:59], s6 offen
    s_mov_b32 s6, 196608
    buffer_load_dwordx4 v[104:107], v38, s[56:59], s6 offen
    s_mov_b32 s6, 229376
    buffer_load_dwordx4 v[108:111], v38, s[56:59], s6 offen
    s_mov_b32 s6, 262144
    buffer_load_dwordx4 v[112:115], v38, s[56:59], s6 offen
    s_mov_b32 s6, 294912
    buffer_load_dwordx4 v[116:119], v38, s[56:59], s6 offen
    v_lshlrev_b32 v12, 4, v1
    s_lshr_b32 s7, s2, 1
    s_and_b32 s8, s2, 1
    s_cmp_eq_u32 s8, 0
    s_cselect_b32 s7, s7, 255
    s_cmp_lt_u32 s7, 27
    s_cselect_b32 s13, 12, 16
    s_cselect_b32 s101, 0, 1
    s_cselect_b32 s98, 0, 0
    s_and_b32 s8, s2, 1
    s_cmp_eq_u32 s8, 0
    s_cselect_b32 s8, 4, 16
    s_cmp_eq_u32 s101, 1
    s_cselect_b32 s13, s8, s13
    s_add_u32 s43, s3, s13
    s_cmp_lt_u32 s3, s13
    s_cselect_b32 s42, s3, 1024
    s_cselect_b32 s43, s43, 1024
    s_mul_i32 s100, s2, 0
    s_mov_b32 s78, 1048576
    s_mov_b32 s79, 0x00020000
    s_cmp_ge_u32 s42, 512
    s_cbranch_scc1 L_ig1
    s_cmp_lt_u32 s42, 256
    s_cselect_b64 s[76:77], s[44:45], s[48:49]
    s_add_u32 s6, s42, s100
    s_and_b32 s6, s6, 255
    s_lshl_b32 s6, s6, 12
    buffer_load_dwordx4 v[48:51], v12, s[76:79], s6 offen offset:0 nt
    buffer_load_dwordx4 v[52:55], v12, s[76:79], s6 offen offset:1024 nt
    buffer_load_dwordx4 v[56:59], v12, s[76:79], s6 offen offset:2048 nt
    buffer_load_dwordx4 v[60:63], v12, s[76:79], s6 offen offset:3072 nt
L_ig1:
    s_cmp_ge_u32 s43, 512
    s_cbranch_scc1 L_ig2
    s_cmp_lt_u32 s43, 256
    s_cselect_b64 s[76:77], s[44:45], s[48:49]
    s_add_u32 s6, s43, s100
    s_and_b32 s6, s6, 255
    s_lshl_b32 s6, s6, 12
    buffer_load_dwordx4 v[64:67], v12, s[76:79], s6 offen offset:0 nt
    buffer_load_dwordx4 v[68:71], v12, s[76:79], s6 offen offset:1024 nt
    buffer_load_dwordx4 v[72:75], v12, s[76:79], s6 offen offset:2048 nt
    buffer_load_dwordx4 v[76:79], v12, s[76:79], s6 offen offset:3072 nt
L_ig2:
    s_cmp_lt_u32 s3, s13
    s_cselect_b32 s98, s98, 0
    s_cmp_eq_u32 s98, 0
    s_cbranch_scc1 L_nopre
    s_lshl_b32 s99, s13, 1
    s_add_u32 s99, s99, s3
    s_lshl_b32 s6, s99, 12
    s_lshl_b32 s8, s3, 12
    s_add_u32 s9, s8, 32768
    s_mov_b32 m0, s9
    s_add_u32 s10, s6, 0
    buffer_load_dwordx4 v12, s[44:47], s10 offen nt lds
    s_add_u32 s9, s8, 33792
    s_mov_b32 m0, s9
    s_add_u32 s10, s6, 1024
    buffer_load_dwordx4 v12, s[44:47], s10 offen nt lds
    s_add_u32 s9, s8, 34816
    s_mov_b32 m0, s9
    s_add_u32 s10, s6, 2048
    buffer_load_dwordx4 v12, s[44:47], s10 offen nt lds
    s_add_u32 s9, s8, 35840
    s_mov_b32 m0, s9
    s_add_u32 s10, s6, 3072
    buffer_load_dwordx4 v12, s[44:47], s10 offen nt lds
L_nopre:
    v_mov_b32 v38, 0
    s_cmp_lt_u32 s7, 27
    s_cselect_b32 s8, 2, 2
    s_mul_i32 s8, s8, s13
    v_mov_b32 v39, s8
    ds_write_b32 v38, v39 offset:29060
    ds_write_b32 v38, v38 offset:29056
    ds_write_b32 v38, v38 offset:29064
    s_cmp_lt_u32 s3, s13
    s_cbranch_scc1 L_w1a
    s_waitcnt vmcnt(10)
L_w1a:
    s_cmp_eq_u32 s98, 1
    s_cbranch_scc1 L_w1b
    s_waitcnt vmcnt(18)
L_w1b:
    s_waitcnt vmcnt(22)
    v_lshlrev_b32 v28, 16, v40
    v_and_b32 v29, 0xffff0000, v40
    v_lshlrev_b32 v30, 16, v41
    v_and_b32 v31, 0xffff0000, v41
    v_lshlrev_b32 v32, 16, v42
    v_and_b32 v33, 0xffff0000, v42
    v_lshlrev_b32 v34, 16, v43
    v_and_b32 v35, 0xffff0000, v43
    v_lshlrev_b32 v45, 16, v44
    v_and_b32 v46, 0xffff0000, v44
    v_add_f32 v36, v28, v29
    v_add_f32 v36, v36, v30
    v_add_f32 v36, v36, v31
    v_add_f32 v36, v36, v32
    v_add_f32 v36, v36, v33
    v_add_f32 v36, v36, v34
    v_add_f32 v36, v36, v35
    v_add_f32 v36, v36, v45
    v_add_f32 v36, v36, v46
    s_nop 1
    v_add_f32_dpp v36, v36, v36 row_ror:8 row_mask:0xf bank_mask:0xf
    s_nop 1
    v_add_f32_dpp v36, v36, v36 row_ror:4 row_mask:0xf bank_mask:0xf
    s_nop 1
    v_add_f32_dpp v36, v36, v36 row_ror:2 row_mask:0xf bank_mask:0xf
    s_nop 1
    v_add_f32_dpp v36, v36, v36 row_ror:1 row_mask:0xf bank_mask:0xf
    s_nop 1
    v_readlane_b32 s8, v36, 0
    v_readlane_b32 s9, v36, 16
    v_readlane_b32 s10, v36, 32
    v_readlane_b32 s11, v36, 48
    s_nop 1
    v_mov_b32 v36, s8
    v_add_f32 v36, s9, v36
    v_add_f32 v36, s10, v36
    v_add_f32 v36, s11, v36
    v_mul_f32 v36, 0x3acccccd, v36
    v_sub_f32 v38, v28, v36
    v_mul_f32 v37, v38, v38
    v_sub_f32 v38, v29, v36
    v_fmac_f32 v37, v38, v38
    v_sub_f32 v38, v30, v36
    v_fmac_f32 v37, v38, v38
    v_sub_f32 v38, v31, v36
    v_fmac_f32 v37, v38, v38
    v_sub_f32 v38, v32, v36
    v_fmac_f32 v37, v38, v38
    v_sub_f32 v38, v33, v36
    v_fmac_f32 v37, v38, v38
    v_sub_f32 v38, v34, v36
    v_fmac_f32 v37, v38, v38
    v_sub_f32 v38, v35, v36
    v_fmac_f32 v37, v38, v38
    v_sub_f32 v38, v45, v36
    v_fmac_f32 v37, v38, v38
    v_sub_f32 v38, v46, v36
    v_fmac_f32 v37, v38, v38
    s_nop 1
    v_add_f32_dpp v37, v37, v37 row_ror:8 row_mask:0xf bank_mask:0xf
    s_nop 1
    v_add_f32_dpp v37, v37, v37 row_ror:4 row_mask:0xf bank_mask:0xf
    s_nop 1
    v_add_f32_dpp v37, v37, v37 row_ror:2 row_mask:0xf bank_mask:0xf
    s_nop 1
    v_add_f32_dpp v37, v37, v37 row_ror:1 row_mask:0xf bank_mask:0xf
    s_nop 1
    v_readlane_b32 s8, v37, 0
    v_readlane_b32 s9, v37, 16
    v_readlane_b32 s10, v37, 32
    v_readlane_b32 s11, v37, 48
    s_nop 1
    v_mov_b32 v37, s8
    v_add_f32 v37, s9, v37
    v_add_f32 v37, s10, v37
    v_add_f32 v37, s11, v37
    v_mul_f32 v37, 0x3acccccd, v37
    v_cvt_pk_bf16_f32 v36, v36, v36
    v_and_b32 v36, 0xffff0000, v36
    v_cvt_pk_bf16_f32 v37, v37, v37
    v_and_b32 v37, 0xffff0000, v37
    v_add_f32 v37, 0x3727c5ac, v37
    v_cvt_pk_bf16_f32 v37, v37, v37
    v_and_b32 v37, 0xffff0000, v37
    v_sqrt_f32 v37, v37
    s_nop 0
    v_cvt_pk_bf16_f32 v37, v37, v37
    v_and_b32 v37, 0xffff0000, v37
    v_rcp_f32 v39, v37
    s_nop 0
    v_sub_f32 v28, v28, v36
    v_cvt_pk_bf16_f32 v28, v28, v28
    v_and_b32 v28, 0xffff0000, v28
    v_mul_f32 v38, v28, v39
    v_fma_f32 v28, -v38, v37, v28
    v_fma_f32 v28, v28, v39, v38
    v_cvt_pk_bf16_f32 v28, v28, v28
    v_sub_f32 v29, v29, v36
    v_cvt_pk_bf16_f32 v29, v29, v29
    v_and_b32 v29, 0xffff0000, v29
    v_mul_f32 v38, v29, v39
    v_fma_f32 v29, -v38, v37, v29
    v_fma_f32 v29, v29, v39, v38
    v_cvt_pk_bf16_f32 v29, v29, v29
    v_sub_f32 v30, v30, v36
    v_cvt_pk_bf16_f32 v30, v30, v30
    v_and_b32 v30, 0xffff0000, v30
    v_mul_f32 v38, v30, v39
    v_fma_f32 v30, -v38, v37, v30
    v_fma_f32 v30, v30, v39, v38
    v_cvt_pk_bf16_f32 v30, v30, v30
    v_sub_f32 v31, v31, v36
    v_cvt_pk_bf16_f32 v31, v31, v31
    v_and_b32 v31, 0xffff0000, v31
    v_mul_f32 v38, v31, v39
    v_fma_f32 v31, -v38, v37, v31
    v_fma_f32 v31, v31, v39, v38
    v_cvt_pk_bf16_f32 v31, v31, v31
    v_sub_f32 v32, v32, v36
    v_cvt_pk_bf16_f32 v32, v32, v32
    v_and_b32 v32, 0xffff0000, v32
    v_mul_f32 v38, v32, v39
    v_fma_f32 v32, -v38, v37, v32
    v_fma_f32 v32, v32, v39, v38
    v_cvt_pk_bf16_f32 v32, v32, v32
    v_sub_f32 v33, v33, v36
    v_cvt_pk_bf16_f32 v33, v33, v33
    v_and_b32 v33, 0xffff0000, v33
    v_mul_f32 v38, v33, v39
    v_fma_f32 v33, -v38, v37, v33
    v_fma_f32 v33, v33, v39, v38
    v_cvt_pk_bf16_f32 v33, v33, v33
    v_sub_f32 v34, v34, v36
    v_cvt_pk_bf16_f32 v34, v34, v34
    v_and_b32 v34, 0xffff0000, v34
    v_mul_f32 v38, v34, v39
    v_fma_f32 v34, -v38, v37, v34
    v_fma_f32 v34, v34, v39, v38
    v_cvt_pk_bf16_f32 v34, v34, v34
    v_sub_f32 v35, v35, v36
    v_cvt_pk_bf16_f32 v35, v35, v35
    v_and_b32 v35, 0xffff0000, v35
    v_mul_f32 v38, v35, v39
    v_fma_f32 v35, -v38, v37, v35
    v_fma_f32 v35, v35, v39, v38
    v_cvt_pk_bf16_f32 v35, v35, v35
    v_sub_f32 v45, v45, v36
    v_cvt_pk_bf16_f32 v45, v45, v45
    v_and_b32 v45, 0xffff0000, v45
    v_mul_f32 v38, v45, v39
    v_fma_f32 v45, -v38, v37, v45
    v_fma_f32 v45, v45, v39, v38
    v_cvt_pk_bf16_f32 v45, v45, v45
    v_sub_f32 v46, v46, v36
    v_cvt_pk_bf16_f32 v46, v46, v46
    v_and_b32 v46, 0xffff0000, v46
    v_mul_f32 v38, v46, v39
    v_fma_f32 v46, -v38, v37, v46
    v_fma_f32 v46, v46, v39, v38
    v_cvt_pk_bf16_f32 v46, v46, v46
    s_and_b32 s8, s3, 7
    s_mul_i32 s8, s8, 2560
    v_lshlrev_b32 v38, 5, v1
    v_add_u32 v38, s8, v38
    ds_write_b128 v38, v[28:31] offset:0
    ds_write_b128 v38, v[32:35] offset:16
    v_lshlrev_b32 v38, 3, v1
    v_add_u32 v38, s8, v38
    v_mov_b32 v42, v45
    v_mov_b32 v43, v46
    ds_write_b64 v38, v[42:43] offset:2048
    s_waitcnt lgkmcnt(0)
    s_barrier
    s_mul_i32 s8, s4, 640
    s_mul_i32 s9, s3, 40
    s_add_u32 s8, s8, s9
    v_lshl_add_u32 v36, v3, 2, v2
    v_add_u32 v36, s8, v36
    v_lshlrev_b32 v36, 2, v36
    ds_read_b32 v37, v36 offset:0
    v_mov_b32 v24, 0
    v_mov_b32 v25, 0
    v_mov_b32 v26, 0
    v_mov_b32 v27, 0
    s_cmp_lt_u32 s3, s13
    s_cbranch_scc1 L_w2a
    s_waitcnt vmcnt(0)
L_w2a:
    s_cmp_eq_u32 s98, 1
    s_cbranch_scc1 L_w2b
    s_waitcnt vmcnt(8)
L_w2b:
    s_waitcnt vmcnt(12) lgkmcnt(0)
    s_nop 1
    v_and_b32_dpp v28, v37, v4 row_newbcast:0 row_mask:0xf bank_mask:0xf
    v_and_b32_dpp v29, v37, v5 row_newbcast:0 row_mask:0xf bank_mask:0xf
    v_and_b32_dpp v30, v37, v6 row_newbcast:0 row_mask:0xf bank_mask:0xf
    v_and_b32_dpp v31, v37, v7 row_newbcast:0 row_mask:0xf bank_mask:0xf
    s_nop 1
    v_mfma_f32_16x16x32_bf16 v[24:27], v[28:31], v[80:83], v[24:27]
    v_and_b32_dpp v32, v37, v4 row_newbcast:1 row_mask:0xf bank_mask:0xf
    v_and_b32_dpp v33, v37, v5 row_newbcast:1 row_mask:0xf bank_mask:0xf
    v_and_b32_dpp v34, v37, v6 row_newbcast:1 row_mask:0xf bank_mask:0xf
    v_and_b32_dpp v35, v37, v7 row_newbcast:1 row_mask:0xf bank_mask:0xf
    s_nop 1
    v_mfma_f32_16x16x32_bf16 v[24:27], v[32:35], v[84:87], v[24:27]
    v_and_b32_dpp v28, v37, v4 row_newbcast:2 row_mask:0xf bank_mask:0xf
    v_and_b32_dpp v29, v37, v5 row_newbcast:2 row_mask:0xf bank_mask:0xf
    v_and_b32_dpp v30, v37, v6 row_newbcast:2 row_mask:0xf bank_mask:0xf
    v_and_b32_dpp v31, v37, v7 row_newbcast:2 row_mask:0xf bank_mask:0xf
    s_nop 1
    v_mfma_f32_16x16x32_bf16 v[24:27], v[28:31], v[88:91], v[24:27]
    v_and_b32_dpp v32, v37, v4 row_newbcast:3 row_mask:0xf bank_mask:0xf
    v_and_b32_dpp v33, v37, v5 row_newbcast:3 row_mask:0xf bank_mask:0xf
    v_and_b32_dpp v34, v37, v6 row_newbcast:3 row_mask:0xf bank_mask:0xf
    v_and_b32_dpp v35, v37, v7 row_newbcast:3 row_mask:0xf bank_mask:0xf
    s_nop 1
    v_mfma_f32_16x16x32_bf16 v[24:27], v[32:35], v[92:95], v[24:27]
    v_and_b32_dpp v28, v37, v4 row_newbcast:4 row_mask:0xf bank_mask:0xf
    v_and_b32_dpp v29, v37, v5 row_newbcast:4 row_mask:0xf bank_mask:0xf
    v_and_b32_dpp v30, v37, v6 row_newbcast:4 row_mask:0xf bank_mask:0xf
    v_and_b32_dpp v31, v37, v7 row_newbcast:4 row_mask:0xf bank_mask:0xf
    s_nop 1
    v_mfma_f32_16x16x32_bf16 v[24:27], v[28:31], v[96:99], v[24:27]
    v_and_b32_dpp v32, v37, v4 row_newbcast:5 row_mask:0xf bank_mask:0xf
    v_and_b32_dpp v33, v37, v5 row_newbcast:5 row_mask:0xf bank_mask:0xf
    v_and_b32_dpp v34, v37, v6 row_newbcast:5 row_mask:0xf bank_mask:0xf
    v_and_b32_dpp v35, v37, v7 row_newbcast:5 row_mask:0xf bank_mask:0xf
    s_nop 1
    v_mfma_f32_16x16x32_bf16 v[24:27], v[32:35], v[100:103], v[24:27]
    v_and_b32_dpp v28, v37, v4 row_newbcast:6 row_mask:0xf bank_mask:0xf
    v_and_b32_dpp v29, v37, v5 row_newbcast:6 row_mask:0xf bank_mask:0xf
    v_and_b32_dpp v30, v37, v6 row_newbcast:6 row_mask:0xf bank_mask:0xf
    v_and_b32_dpp v31, v37, v7 row_newbcast:6 row_mask:0xf bank_mask:0xf
    s_nop 1
    v_mfma_f32_16x16x32_bf16 v[24:27], v[28:31], v[104:107], v[24:27]
    v_and_b32_dpp v32, v37, v4 row_newbcast:7 row_mask:0xf bank_mask:0xf
    v_and_b32_dpp v33, v37, v5 row_newbcast:7 row_mask:0xf bank_mask:0xf
    v_and_b32_dpp v34, v37, v6 row_newbcast:7 row_mask:0xf bank_mask:0xf
    v_and_b32_dpp v35, v37, v7 row_newbcast:7 row_mask:0xf bank_mask:0xf
    s_nop 1
    v_mfma_f32_16x16x32_bf16 v[24:27], v[32:35], v[108:111], v[24:27]
    v_and_b32_dpp v28, v37, v4 row_newbcast:8 row_mask:0xf bank_mask:0xf
    v_and_b32_dpp v29, v37, v5 row_newbcast:8 row_mask:0xf bank_mask:0xf
    v_and_b32_dpp v30, v37, v6 row_newbcast:8 row_mask:0xf bank_mask:0xf
    v_and_b32_dpp v31, v37, v7 row_newbcast:8 row_mask:0xf bank_mask:0xf
    s_nop 1
    v_mfma_f32_16x16x32_bf16 v[24:27], v[28:31], v[112:115], v[24:27]
    v_and_b32_dpp v32, v37, v4 row_newbcast:9 row_mask:0xf bank_mask:0xf
    v_and_b32_dpp v33, v37, v5 row_newbcast:9 row_mask:0xf bank_mask:0xf
    v_and_b32_dpp v34, v37, v6 row_newbcast:9 row_mask:0xf bank_mask:0xf
    v_and_b32_dpp v35, v37, v7 row_newbcast:9 row_mask:0xf bank_mask:0xf
    s_nop 1
    v_mfma_f32_16x16x32_bf16 v[24:27], v[32:35], v[116:119], v[24:27]
    v_lshlrev_b32 v38, 5, v3
    v_lshl_add_u32 v38, v2, 4, v38
    s_lshl_b32 s8, s3, 9
    v_add_u32 v38, s8, v38
    s_nop 7
    s_mov_b32 exec_hi, 0
    ds_write_b128 v38, v[24:27] offset:20480
    s_mov_b64 exec, -1
    s_waitcnt lgkmcnt(0)
    s_barrier
    s_cmp_ge_u32 s3, 2
    s_cbranch_scc1 L_q_skip
    v_lshlrev_b32 v36, 2, v0
    ds_read_b32 v80, v36 offset:20480
    ds_read_b32 v81, v36 offset:20992
    ds_read_b32 v82, v36 offset:21504
    ds_read_b32 v83, v36 offset:22016
    ds_read_b32 v84, v36 offset:22528
    ds_read_b32 v85, v36 offset:23040
    ds_read_b32 v86, v36 offset:23552
    ds_read_b32 v87, v36 offset:24064
    ds_read_b32 v88, v36 offset:24576
    ds_read_b32 v89, v36 offset:25088
    ds_read_b32 v90, v36 offset:25600
    ds_read_b32 v91, v36 offset:26112
    ds_read_b32 v92, v36 offset:26624
    ds_read_b32 v93, v36 offset:27136
    ds_read_b32 v94, v36 offset:27648
    ds_read_b32 v95, v36 offset:28160
    s_waitcnt lgkmcnt(0)
    v_add_f32 v80, v80, v81
    v_add_f32 v80, v80, v82
    v_add_f32 v80, v80, v83
    v_add_f32 v80, v80, v84
    v_add_f32 v80, v80, v85
    v_add_f32 v80, v80, v86
    v_add_f32 v80, v80, v87
    v_add_f32 v80, v80, v88
    v_add_f32 v80, v80, v89
    v_add_f32 v80, v80, v90
    v_add_f32 v80, v80, v91
    v_add_f32 v80, v80, v92
    v_add_f32 v80, v80, v93
    v_add_f32 v80, v80, v94
    v_add_f32 v80, v80, v95
    v_cvt_pk_bf16_f32 v80, v80, v80
    v_lshlrev_b32 v36, 1, v0
    ds_write_b16 v36, v80 offset:28672
    s_waitcnt lgkmcnt(0)
L_q_skip:
    s_barrier
    v_lshlrev_b32 v36, 4, v3
    ds_read_b128 v[16:19], v36 offset:28672
L_kinit:
    s_waitcnt lgkmcnt(0)
    v_mov_b32 v24, 0
    v_mov_b32 v25, 0
    v_mov_b32 v26, 0
    v_mov_b32 v27, 0
    v_mov_b32 v21, 1
    v_mov_b32 v23, 0
    v_mov_b32 v46, 0xff800000
    v_mov_b32 v47, 0
    v_lshl_add_u32 v15, v3, 2, v2
    v_lshlrev_b32 v15, 2, v15
    v_add_u32 v15, 147456, v15
    v_and_b32 v20, 3, v3
    v_lshl_add_u32 v20, v20, 2, v2
    v_lshlrev_b32 v20, 2, v20
    v_add_u32 v20, 147456, v20
    v_and_b32 v36, 3, v3
    v_cmp_eq_u32 s[80:81], 1, v36
    v_cmp_eq_u32 s[82:83], 2, v36
    v_cmp_eq_u32 s[84:85], 3, v36
    s_cmp_ge_u32 s3, s13
    s_cselect_b32 s8, s101, 0
    s_cmp_eq_u32 s8, 1
    s_cbranch_scc1 L_mid0
    s_cmp_ge_u32 s3, s13
    s_cbranch_scc1 L_ffn
    s_mov_b64 exec, 1
    ds_add_rtn_u32 v14, v23, v21 offset:29060
    s_mov_b64 exec, -1
    s_cmp_lt_u32 s42, 1024
    s_cbranch_scc1 L_kpre
    s_waitcnt lgkmcnt(0)
    v_readfirstlane_b32 s42, v14
    s_nop 3
    s_cmp_ge_u32 s42, 512
    s_cbranch_scc1 L_ig3
    s_cmp_lt_u32 s42, 256
    s_cselect_b64 s[76:77], s[44:45], s[48:49]
    s_add_u32 s6, s42, s100
    s_and_b32 s6, s6, 255
    s_lshl_b32 s6, s6, 12
    buffer_load_dwordx4 v[48:51], v12, s[76:79], s6 offen offset:0 nt
    buffer_load_dwordx4 v[52:55], v12, s[76:79], s6 offen offset:1024 nt
    buffer_load_dwordx4 v[56:59], v12, s[76:79], s6 offen offset:2048 nt
    buffer_load_dwordx4 v[60:63], v12, s[76:79], s6 offen offset:3072 nt
L_ig3:
    s_mov_b64 exec, 1
    ds_add_rtn_u32 v14, v23, v21 offset:29060
    s_mov_b64 exec, -1
    s_waitcnt lgkmcnt(0)
    v_readfirstlane_b32 s43, v14
    s_nop 3
    s_cmp_ge_u32 s43, 512
    s_cbranch_scc1 L_ig4
    s_cmp_lt_u32 s43, 256
    s_cselect_b64 s[76:77], s[44:45], s[48:49]
    s_add_u32 s6, s43, s100
    s_and_b32 s6, s6, 255
    s_lshl_b32 s6, s6, 12
    buffer_load_dwordx4 v[64:67], v12, s[76:79], s6 offen offset:0 nt
    buffer_load_dwordx4 v[68:71], v12, s[76:79], s6 offen offset:1024 nt
    buffer_load_dwordx4 v[72:75], v12, s[76:79], s6 offen offset:2048 nt
    buffer_load_dwordx4 v[76:79], v12, s[76:79], s6 offen offset:3072 nt
L_ig4:
    s_mov_b64 exec, 1
    ds_add_rtn_u32 v14, v23, v21 offset:29060
    s_mov_b64 exec, -1
L_kpre:
    s_cmp_eq_u32 s98, 0
    s_cbranch_scc1 L_kwo
    s_mov_b32 s98, 0
    s_lshl_b32 s8, s3, 12
    v_add_u32 v41, s8, v12
    s_waitcnt vmcnt(0)
    ds_read_b128 v[80:83], v41 offset:32768
    ds_read_b128 v[84:87], v41 offset:33792
    ds_read_b128 v[88:91], v41 offset:34816
    ds_read_b128 v[92:95], v41 offset:35840
    s_lshl_b32 s8, s99, 6
    v_add_u32 v40, s8, v15
    s_waitcnt lgkmcnt(0)
    v_mov_b32 v36, 0
    v_mov_b32 v37, 0
    v_mov_b32 v38, 0
    v_mov_b32 v39, 0
    v_dot2c_f32_bf16 v36, v80, v16
    v_dot2c_f32_bf16 v37, v84, v16
    v_dot2c_f32_bf16 v38, v88, v16
    v_dot2c_f32_bf16 v39, v92, v16
    v_dot2c_f32_bf16 v36, v81, v17
    v_dot2c_f32_bf16 v37, v85, v17
    v_dot2c_f32_bf16 v38, v89, v17
    v_dot2c_f32_bf16 v39, v93, v17
    v_dot2c_f32_bf16 v36, v82, v18
    v_dot2c_f32_bf16 v37, v86, v18
    v_dot2c_f32_bf16 v38, v90, v18
    v_dot2c_f32_bf16 v39, v94, v18
    v_dot2c_f32_bf16 v36, v83, v19
    v_dot2c_f32_bf16 v37, v87, v19
    v_dot2c_f32_bf16 v38, v91, v19
    v_dot2c_f32_bf16 v39, v95, v19
    s_nop 2
    v_add_f32_dpp v36, v36, v36 row_ror:8 row_mask:0xf bank_mask:0xf
    v_add_f32_dpp v37, v37, v37 row_ror:8 row_mask:0xf bank_mask:0xf
    v_add_f32_dpp v38, v38, v38 row_ror:8 row_mask:0xf bank_mask:0xf
    v_add_f32_dpp v39, v39, v39 row_ror:8 row_mask:0xf bank_mask:0xf
    v_add_f32_dpp v36, v36, v36 row_ror:4 row_mask:0xf bank_mask:0xf
    v_add_f32_dpp v37, v37, v37 row_ror:4 row_mask:0xf bank_mask:0xf
    v_add_f32_dpp v38, v38, v38 row_ror:4 row_mask:0xf bank_mask:0xf
    v_add_f32_dpp v39, v39, v39 row_ror:4 row_mask:0xf bank_mask:0xf
    v_add_f32_dpp v36, v36, v36 row_ror:2 row_mask:0xf bank_mask:0xf
    v_add_f32_dpp v37, v37, v37 row_ror:2 row_mask:0xf bank_mask:0xf
    v_add_f32_dpp v38, v38, v38 row_ror:2 row_mask:0xf bank_mask:0xf
    v_add_f32_dpp v39, v39, v39 row_ror:2 row_mask:0xf bank_mask:0xf
    v_add_f32_dpp v36, v36, v36 row_ror:1 row_mask:0xf bank_mask:0xf
    v_add_f32_dpp v37, v37, v37 row_ror:1 row_mask:0xf bank_mask:0xf
    v_add_f32_dpp v38, v38, v38 row_ror:1 row_mask:0xf bank_mask:0xf
    v_add_f32_dpp v39, v39, v39 row_ror:1 row_mask:0xf bank_mask:0xf
    v_cndmask_b32 v36, v36, v37, s[80:81]
    v_cndmask_b32 v36, v36, v38, s[82:83]
    v_cndmask_b32 v36, v36, v39, s[84:85]
    v_cvt_pk_bf16_f32 v36, v36, v36
    v_and_b32 v36, 0xffff0000, v36
    v_mul_f32 v36, 0x3db504f3, v36
    v_cvt_pk_bf16_f32 v36, v36, v36
    v_and_b32 v36, 0xffff0000, v36
    v_mul_f32 v36, 0x3fb8aa3b, v36
    v_max_f32 v46, v46, v36
    s_mov_b32 exec_lo, 0x000f000f
    s_mov_b32 exec_hi, 0x000f000f
    ds_write_b32 v40, v36
    s_mov_b64 exec, -1
L_kwo:
L_k0:
    s_cmp_ge_u32 s42, 256
    s_cbranch_scc1 L_mid0
    s_waitcnt vmcnt(4)
    v_mov_b32 v36, 0
    v_mov_b32 v37, 0
    v_mov_b32 v38, 0
    v_mov_b32 v39, 0
    v_dot2c_f32_bf16 v36, v48, v16
    v_dot2c_f32_bf16 v37, v52, v16
    v_dot2c_f32_bf16 v38, v56, v16
    v_dot2c_f32_bf16 v39, v60, v16
    v_dot2c_f32_bf16 v36, v49, v17
    v_dot2c_f32_bf16 v37, v53, v17
    v_dot2c_f32_bf16 v38, v57, v17
    v_dot2c_f32_bf16 v39, v61, v17
    v_dot2c_f32_bf16 v36, v50, v18
    v_dot2c_f32_bf16 v37, v54, v18
    v_dot2c_f32_bf16 v38, v58, v18
    v_dot2c_f32_bf16 v39, v62, v18
    v_dot2c_f32_bf16 v36, v51, v19
    v_dot2c_f32_bf16 v37, v55, v19
    v_dot2c_f32_bf16 v38, v59, v19
    v_dot2c_f32_bf16 v39, v63, v19
    s_waitcnt lgkmcnt(0)
    v_readfirstlane_b32 s9, v14
    s_lshl_b32 s8, s42, 6
    v_add_u32 v40, s8, v15
    s_mov_b32 s42, s9
    s_cmp_ge_u32 s42, 512
    s_cbranch_scc1 L_ig5
    s_cmp_lt_u32 s42, 256
    s_cselect_b64 s[76:77], s[44:45], s[48:49]
    s_add_u32 s6, s42, s100
    s_and_b32 s6, s6, 255
    s_lshl_b32 s6, s6, 12
    buffer_load_dwordx4 v[48:51], v12, s[76:79], s6 offen offset:0 nt
    buffer_load_dwordx4 v[52:55], v12, s[76:79], s6 offen offset:1024 nt
    buffer_load_dwordx4 v[56:59], v12, s[76:79], s6 offen offset:2048 nt
    buffer_load_dwordx4 v[60:63], v12, s[76:79], s6 offen offset:3072 nt
L_ig5:
    s_mov_b64 exec, 1
    ds_add_rtn_u32 v14, v23, v21 offset:29060
    s_mov_b64 exec, -1
    v_add_f32_dpp v36, v36, v36 row_ror:8 row_mask:0xf bank_mask:0xf
    v_add_f32_dpp v37, v37, v37 row_ror:8 row_mask:0xf bank_mask:0xf
    v_add_f32_dpp v38, v38, v38 row_ror:8 row_mask:0xf bank_mask:0xf
    v_add_f32_dpp v39, v39, v39 row_ror:8 row_mask:0xf bank_mask:0xf
    v_add_f32_dpp v36, v36, v36 row_ror:4 row_mask:0xf bank_mask:0xf
    v_add_f32_dpp v37, v37, v37 row_ror:4 row_mask:0xf bank_mask:0xf
    v_add_f32_dpp v38, v38, v38 row_ror:4 row_mask:0xf bank_mask:0xf
    v_add_f32_dpp v39, v39, v39 row_ror:4 row_mask:0xf bank_mask:0xf
    v_add_f32_dpp v36, v36, v36 row_ror:2 row_mask:0xf bank_mask:0xf
    v_add_f32_dpp v37, v37, v37 row_ror:2 row_mask:0xf bank_mask:0xf
    v_add_f32_dpp v38, v38, v38 row_ror:2 row_mask:0xf bank_mask:0xf
    v_add_f32_dpp v39, v39, v39 row_ror:2 row_mask:0xf bank_mask:0xf
    v_add_f32_dpp v36, v36, v36 row_ror:1 row_mask:0xf bank_mask:0xf
    v_add_f32_dpp v37, v37, v37 row_ror:1 row_mask:0xf bank_mask:0xf
    v_add_f32_dpp v38, v38, v38 row_ror:1 row_mask:0xf bank_mask:0xf
    v_add_f32_dpp v39, v39, v39 row_ror:1 row_mask:0xf bank_mask:0xf
    v_cndmask_b32 v36, v36, v37, s[80:81]
    v_cndmask_b32 v36, v36, v38, s[82:83]
    v_cndmask_b32 v36, v36, v39, s[84:85]
    v_cvt_pk_bf16_f32 v36, v36, v36
    v_and_b32 v36, 0xffff0000, v36
    v_mul_f32 v36, 0x3db504f3, v36
    v_cvt_pk_bf16_f32 v36, v36, v36
    v_and_b32 v36, 0xffff0000, v36
    v_mul_f32 v36, 0x3fb8aa3b, v36
    v_max_f32 v46, v46, v36
    s_mov_b32 exec_lo, 0x000f000f
    s_mov_b32 exec_hi, 0x000f000f
    ds_write_b32 v40, v36
    s_mov_b64 exec, -1
L_k1:
    s_cmp_ge_u32 s43, 256
    s_cbranch_scc1 L_mid1
    s_waitcnt vmcnt(4)
    v_mov_b32 v36, 0
    v_mov_b32 v37, 0
    v_mov_b32 v38, 0
    v_mov_b32 v39, 0
    v_dot2c_f32_bf16 v36, v64, v16
    v_dot2c_f32_bf16 v37, v68, v16
    v_dot2c_f32_bf16 v38, v72, v16
    v_dot2c_f32_bf16 v39, v76, v16
    v_dot2c_f32_bf16 v36, v65, v17
    v_dot2c_f32_bf16 v37, v69, v17
    v_dot2c_f32_bf16 v38, v73, v17
    v_dot2c_f32_bf16 v39, v77, v17
    v_dot2c_f32_bf16 v36, v66, v18
    v_dot2c_f32_bf16 v37, v70, v18
    v_dot2c_f32_bf16 v38, v74, v18
    v_dot2c_f32_bf16 v39, v78, v18
    v_dot2c_f32_bf16 v36, v67, v19
    v_dot2c_f32_bf16 v37, v71, v19
    v_dot2c_f32_bf16 v38, v75, v19
    v_dot2c_f32_bf16 v39, v79, v19
    s_waitcnt lgkmcnt(0)
    v_readfirstlane_b32 s9, v14
    s_lshl_b32 s8, s43, 6
    v_add_u32 v40, s8, v15
    s_mov_b32 s43, s9
    s_cmp_ge_u32 s43, 512
    s_cbranch_scc1 L_ig6
    s_cmp_lt_u32 s43, 256
    s_cselect_b64 s[76:77], s[44:45], s[48:49]
    s_add_u32 s6, s43, s100
    s_and_b32 s6, s6, 255
    s_lshl_b32 s6, s6, 12
    buffer_load_dwordx4 v[64:67], v12, s[76:79], s6 offen offset:0 nt
    buffer_load_dwordx4 v[68:71], v12, s[76:79], s6 offen offset:1024 nt
    buffer_load_dwordx4 v[72:75], v12, s[76:79], s6 offen offset:2048 nt
    buffer_load_dwordx4 v[76:79], v12, s[76:79], s6 offen offset:3072 nt
L_ig6:
    s_mov_b64 exec, 1
    ds_add_rtn_u32 v14, v23, v21 offset:29060
    s_mov_b64 exec, -1
    v_add_f32_dpp v36, v36, v36 row_ror:8 row_mask:0xf bank_mask:0xf
    v_add_f32_dpp v37, v37, v37 row_ror:8 row_mask:0xf bank_mask:0xf
    v_add_f32_dpp v38, v38, v38 row_ror:8 row_mask:0xf bank_mask:0xf
    v_add_f32_dpp v39, v39, v39 row_ror:8 row_mask:0xf bank_mask:0xf
    v_add_f32_dpp v36, v36, v36 row_ror:4 row_mask:0xf bank_mask:0xf
    v_add_f32_dpp v37, v37, v37 row_ror:4 row_mask:0xf bank_mask:0xf
    v_add_f32_dpp v38, v38, v38 row_ror:4 row_mask:0xf bank_mask:0xf
    v_add_f32_dpp v39, v39, v39 row_ror:4 row_mask:0xf bank_mask:0xf
    v_add_f32_dpp v36, v36, v36 row_ror:2 row_mask:0xf bank_mask:0xf
    v_add_f32_dpp v37, v37, v37 row_ror:2 row_mask:0xf bank_mask:0xf
    v_add_f32_dpp v38, v38, v38 row_ror:2 row_mask:0xf bank_mask:0xf
    v_add_f32_dpp v39, v39, v39 row_ror:2 row_mask:0xf bank_mask:0xf
    v_add_f32_dpp v36, v36, v36 row_ror:1 row_mask:0xf bank_mask:0xf
    v_add_f32_dpp v37, v37, v37 row_ror:1 row_mask:0xf bank_mask:0xf
    v_add_f32_dpp v38, v38, v38 row_ror:1 row_mask:0xf bank_mask:0xf
    v_add_f32_dpp v39, v39, v39 row_ror:1 row_mask:0xf bank_mask:0xf
    v_cndmask_b32 v36, v36, v37, s[80:81]
    v_cndmask_b32 v36, v36, v38, s[82:83]
    v_cndmask_b32 v36, v36, v39, s[84:85]
    v_cvt_pk_bf16_f32 v36, v36, v36
    v_and_b32 v36, 0xffff0000, v36
    v_mul_f32 v36, 0x3db504f3, v36
    v_cvt_pk_bf16_f32 v36, v36, v36
    v_and_b32 v36, 0xffff0000, v36
    v_mul_f32 v36, 0x3fb8aa3b, v36
    v_max_f32 v46, v46, v36
    s_mov_b32 exec_lo, 0x000f000f
    s_mov_b32 exec_hi, 0x000f000f
    ds_write_b32 v40, v36
    s_mov_b64 exec, -1
    s_branch L_k0
L_ffn:
    s_setprio 3
    s_sub_u32 s14, s3, 12
    s_lshl_b32 s8, s7, 7
    s_add_u32 s10, s28, s8
    s_addc_u32 s11, s29, 0
    s_mov_b32 s64, s10
    s_and_b32 s65, s11, 0xffff
    s_mov_b32 s66, 0
    s_mov_b32 s67, 0x00020000
    s_sub_u32 s66, 2211840, s8
    s_mul_i32 s8, s7, 81920
    s_add_u32 s10, s32, s8
    s_addc_u32 s11, s33, 0
    s_mov_b32 s68, s10
    s_and_b32 s69, s11, 0xffff
    s_mov_b32 s70, 81920
    s_mov_b32 s71, 0x00020000
    v_lshrrev_b32 v39, 3, v3
    v_lshl_add_u32 v39, v2, 1, v39
    s_mul_i32 s8, s14, 160
    v_add_u32 v36, s8, v39
    s_movk_i32 s9, 3456
    v_mul_lo_u32 v37, v36, s9
    v_and_b32 v40, 7, v3
    v_lshl_add_u32 v37, v40, 4, v37
    s_mov_b32 s6, 0
    buffer_load_dwordx4 v[48:51], v37, s[64:67], s6 offen
    s_mov_b32 s6, 27648
    buffer_load_dwordx4 v[52:55], v37, s[64:67], s6 offen
    s_mov_b32 s6, 55296
    buffer_load_dwordx4 v[56:59], v37, s[64:67], s6 offen
    s_mov_b32 s6, 82944
    buffer_load_dwordx4 v[60:63], v37, s[64:67], s6 offen
    s_mov_b32 s6, 110592
    buffer_load_dwordx4 v[64:67], v37, s[64:67], s6 offen
    s_mov_b32 s6, 138240
    buffer_load_dwordx4 v[68:71], v37, s[64:67], s6 offen
    s_mov_b32 s6, 165888
    buffer_load_dwordx4 v[72:75], v37, s[64:67], s6 offen
    s_mov_b32 s6, 193536
    buffer_load_dwordx4 v[76:79], v37, s[64:67], s6 offen
    s_mov_b32 s6, 221184
    buffer_load_dwordx4 v[80:83], v37, s[64:67], s6 offen
    s_mov_b32 s6, 248832
    buffer_load_dwordx4 v[84:87], v37, s[64:67], s6 offen
    s_mov_b32 s6, 276480
    buffer_load_dwordx4 v[88:91], v37, s[64:67], s6 offen
    s_mov_b32 s6, 304128
    buffer_load_dwordx4 v[92:95], v37, s[64:67], s6 offen
    s_mov_b32 s6, 331776
    buffer_load_dwordx4 v[96:99], v37, s[64:67], s6 offen
    s_mov_b32 s6, 359424
    buffer_load_dwordx4 v[100:103], v37, s[64:67], s6 offen
    s_mov_b32 s6, 387072
    buffer_load_dwordx4 v[104:107], v37, s[64:67], s6 offen
    s_mov_b32 s6, 414720
    buffer_load_dwordx4 v[108:111], v37, s[64:67], s6 offen
    s_mov_b32 s6, 442368
    buffer_load_dwordx4 v[112:115], v37, s[64:67], s6 offen
    s_mov_b32 s6, 470016
    buffer_load_dwordx4 v[116:119], v37, s[64:67], s6 offen
    s_mov_b32 s6, 497664
    buffer_load_dwordx4 v[120:123], v37, s[64:67], s6 offen
    s_mov_b32 s6, 525312
    buffer_load_dwordx4 v[124:127], v37, s[64:67], s6 offen
    s_lshl_b32 s8, s7, 7
    v_lshlrev_b32 v37, 1, v1
    v_add_u32 v37, s8, v37
    global_load_ushort v13, v37, s[30:31]
    v_lshlrev_b32 v37, 4, v1
    s_mul_i32 s8, s14, 20480
    s_add_u32 s9, s8, 0
    s_add_u32 s10, s9, 32768
    s_mov_b32 m0, s10
    s_nop 0
    buffer_load_dwordx4 v37, s[68:71], s9 offen lds
    s_add_u32 s9, s8, 1024
    s_add_u32 s10, s9, 32768
    s_mov_b32 m0, s10
    s_nop 0
    buffer_load_dwordx4 v37, s[68:71], s9 offen lds
    s_add_u32 s9, s8, 2048
    s_add_u32 s10, s9, 32768
    s_mov_b32 m0, s10
    s_nop 0
    buffer_load_dwordx4 v37, s[68:71], s9 offen lds
    s_add_u32 s9, s8, 3072
    s_add_u32 s10, s9, 32768
    s_mov_b32 m0, s10
    s_nop 0
    buffer_load_dwordx4 v37, s[68:71], s9 offen lds
    s_add_u32 s9, s8, 4096
    s_add_u32 s10, s9, 32768
    s_mov_b32 m0, s10
    s_nop 0
    buffer_load_dwordx4 v37, s[68:71], s9 offen lds
    s_add_u32 s9, s8, 5120
    s_add_u32 s10, s9, 32768
    s_mov_b32 m0, s10
    s_nop 0
    buffer_load_dwordx4 v37, s[68:71], s9 offen lds
    s_add_u32 s9, s8, 6144
    s_add_u32 s10, s9, 32768
    s_mov_b32 m0, s10
    s_nop 0
    buffer_load_dwordx4 v37, s[68:71], s9 offen lds
    s_add_u32 s9, s8, 7168
    s_add_u32 s10, s9, 32768
    s_mov_b32 m0, s10
    s_nop 0
    buffer_load_dwordx4 v37, s[68:71], s9 offen lds
    s_add_u32 s9, s8, 8192
    s_add_u32 s10, s9, 32768
    s_mov_b32 m0, s10
    s_nop 0
    buffer_load_dwordx4 v37, s[68:71], s9 offen lds
    s_add_u32 s9, s8, 9216
    s_add_u32 s10, s9, 32768
    s_mov_b32 m0, s10
    s_nop 0
    buffer_load_dwordx4 v37, s[68:71], s9 offen lds
    s_add_u32 s9, s8, 10240
    s_add_u32 s10, s9, 32768
    s_mov_b32 m0, s10
    s_nop 0
    buffer_load_dwordx4 v37, s[68:71], s9 offen lds
    s_add_u32 s9, s8, 11264
    s_add_u32 s10, s9, 32768
    s_mov_b32 m0, s10
    s_nop 0
    buffer_load_dwordx4 v37, s[68:71], s9 offen lds
    s_add_u32 s9, s8, 12288
    s_add_u32 s10, s9, 32768
    s_mov_b32 m0, s10
    s_nop 0
    buffer_load_dwordx4 v37, s[68:71], s9 offen lds
    s_add_u32 s9, s8, 13312
    s_add_u32 s10, s9, 32768
    s_mov_b32 m0, s10
    s_nop 0
    buffer_load_dwordx4 v37, s[68:71], s9 offen lds
    s_add_u32 s9, s8, 14336
    s_add_u32 s10, s9, 32768
    s_mov_b32 m0, s10
    s_nop 0
    buffer_load_dwordx4 v37, s[68:71], s9 offen lds
    s_add_u32 s9, s8, 15360
    s_add_u32 s10, s9, 32768
    s_mov_b32 m0, s10
    s_nop 0
    buffer_load_dwordx4 v37, s[68:71], s9 offen lds
    s_add_u32 s9, s8, 16384
    s_add_u32 s10, s9, 32768
    s_mov_b32 m0, s10
    s_nop 0
    buffer_load_dwordx4 v37, s[68:71], s9 offen lds
    s_add_u32 s9, s8, 17408
    s_add_u32 s10, s9, 32768
    s_mov_b32 m0, s10
    s_nop 0
    buffer_load_dwordx4 v37, s[68:71], s9 offen lds
    s_add_u32 s9, s8, 18432
    s_add_u32 s10, s9, 32768
    s_mov_b32 m0, s10
    s_nop 0
    buffer_load_dwordx4 v37, s[68:71], s9 offen lds
    s_add_u32 s9, s8, 19456
    s_add_u32 s10, s9, 32768
    s_mov_b32 m0, s10
    s_nop 0
    buffer_load_dwordx4 v37, s[68:71], s9 offen lds
    v_lshlrev_b32 v36, 2, v36
    s_lshl_b32 s8, s14, 11
    s_add_u32 s8, s8, 114688
    v_lshlrev_b32 v47, 5, v3
    v_add_u32 v47, s8, v47
    v_and_b32 v37, 1, v2
    v_lshl_add_u32 v47, v37, 4, v47
    v_lshrrev_b32 v37, 1, v2
    v_lshl_add_u32 v47, v37, 9, v47
    s_waitcnt vmcnt(21)
    v_mov_b32 v16, 0
    v_mov_b32 v17, 0
    v_mov_b32 v18, 0
    v_mov_b32 v19, 0
    v_mov_b32 v20, 0
    v_mov_b32 v21, 0
    v_mov_b32 v22, 0
    v_mov_b32 v23, 0
    v_mov_b32 v24, 0
    v_mov_b32 v25, 0
    v_mov_b32 v26, 0
    v_mov_b32 v27, 0
    v_mov_b32 v32, 0
    v_mov_b32 v33, 0
    v_mov_b32 v34, 0
    v_mov_b32 v35, 0
    ds_read_b32 v37, v36 offset:0
    ds_read_b32 v38, v36 offset:32
    ds_read_b32 v39, v36 offset:64
    ds_read_b32 v40, v36 offset:96
    ds_read_b32 v41, v36 offset:128
    ds_read_b32 v42, v36 offset:160
    ds_read_b32 v43, v36 offset:192
    ds_read_b32 v44, v36 offset:224
    ds_read_b32 v45, v36 offset:256
    ds_read_b32 v46, v36 offset:288
    s_waitcnt lgkmcnt(9)
    v_and_b32 v28, v37, v8
    v_and_b32 v29, v37, v9
    v_and_b32 v30, v37, v10
    v_and_b32 v31, v37, v11
    s_nop 1
    v_mfma_f32_16x16x32_bf16 v[16:19], v[28:31], v[48:51], v[16:19]
    s_waitcnt lgkmcnt(8)
    v_and_b32 v28, v38, v8
    v_and_b32 v29, v38, v9
    v_and_b32 v30, v38, v10
    v_and_b32 v31, v38, v11
    s_nop 1
    v_mfma_f32_16x16x32_bf16 v[16:19], v[28:31], v[52:55], v[16:19]
    s_waitcnt lgkmcnt(7)
    v_and_b32 v28, v39, v8
    v_and_b32 v29, v39, v9
    v_and_b32 v30, v39, v10
    v_and_b32 v31, v39, v11
    s_nop 1
    v_mfma_f32_16x16x32_bf16 v[16:19], v[28:31], v[56:59], v[16:19]
    s_waitcnt lgkmcnt(6)
    v_and_b32 v28, v40, v8
    v_and_b32 v29, v40, v9
    v_and_b32 v30, v40, v10
    v_and_b32 v31, v40, v11
    s_nop 1
    v_mfma_f32_16x16x32_bf16 v[16:19], v[28:31], v[60:63], v[16:19]
    s_waitcnt lgkmcnt(5)
    v_and_b32 v28, v41, v8
    v_and_b32 v29, v41, v9
    v_and_b32 v30, v41, v10
    v_and_b32 v31, v41, v11
    s_nop 1
    v_mfma_f32_16x16x32_bf16 v[16:19], v[28:31], v[64:67], v[16:19]
    s_waitcnt lgkmcnt(4)
    v_and_b32 v28, v42, v8
    v_and_b32 v29, v42, v9
    v_and_b32 v30, v42, v10
    v_and_b32 v31, v42, v11
    s_nop 1
    v_mfma_f32_16x16x32_bf16 v[16:19], v[28:31], v[68:71], v[16:19]
    s_waitcnt lgkmcnt(3)
    v_and_b32 v28, v43, v8
    v_and_b32 v29, v43, v9
    v_and_b32 v30, v43, v10
    v_and_b32 v31, v43, v11
    s_nop 1
    v_mfma_f32_16x16x32_bf16 v[16:19], v[28:31], v[72:75], v[16:19]
    s_waitcnt lgkmcnt(2)
    v_and_b32 v28, v44, v8
    v_and_b32 v29, v44, v9
    v_and_b32 v30, v44, v10
    v_and_b32 v31, v44, v11
    s_nop 1
    v_mfma_f32_16x16x32_bf16 v[16:19], v[28:31], v[76:79], v[16:19]
    s_waitcnt lgkmcnt(1)
    v_and_b32 v28, v45, v8
    v_and_b32 v29, v45, v9
    v_and_b32 v30, v45, v10
    v_and_b32 v31, v45, v11
    s_nop 1
    v_mfma_f32_16x16x32_bf16 v[16:19], v[28:31], v[80:83], v[16:19]
    s_waitcnt lgkmcnt(0)
    v_and_b32 v28, v46, v8
    v_and_b32 v29, v46, v9
    v_and_b32 v30, v46, v10
    v_and_b32 v31, v46, v11
    s_nop 1
    v_mfma_f32_16x16x32_bf16 v[16:19], v[28:31], v[84:87], v[16:19]
    ds_read_b32 v37, v36 offset:320
    ds_read_b32 v38, v36 offset:352
    ds_read_b32 v39, v36 offset:384
    ds_read_b32 v40, v36 offset:416
    ds_read_b32 v41, v36 offset:448
    ds_read_b32 v42, v36 offset:480
    ds_read_b32 v43, v36 offset:512
    ds_read_b32 v44, v36 offset:544
    ds_read_b32 v45, v36 offset:576
    ds_read_b32 v46, v36 offset:608
    s_waitcnt lgkmcnt(9)
    v_and_b32 v28, v37, v8
    v_and_b32 v29, v37, v9
    v_and_b32 v30, v37, v10
    v_and_b32 v31, v37, v11
    s_nop 1
    v_mfma_f32_16x16x32_bf16 v[16:19], v[28:31], v[88:91], v[16:19]
    s_waitcnt lgkmcnt(8)
    v_and_b32 v28, v38, v8
    v_and_b32 v29, v38, v9
    v_and_b32 v30, v38, v10
    v_and_b32 v31, v38, v11
    s_nop 1
    v_mfma_f32_16x16x32_bf16 v[16:19], v[28:31], v[92:95], v[16:19]
    s_waitcnt lgkmcnt(7)
    v_and_b32 v28, v39, v8
    v_and_b32 v29, v39, v9
    v_and_b32 v30, v39, v10
    v_and_b32 v31, v39, v11
    s_nop 1
    v_mfma_f32_16x16x32_bf16 v[16:19], v[28:31], v[96:99], v[16:19]
    s_waitcnt lgkmcnt(6)
    v_and_b32 v28, v40, v8
    v_and_b32 v29, v40, v9
    v_and_b32 v30, v40, v10
    v_and_b32 v31, v40, v11
    s_nop 1
    v_mfma_f32_16x16x32_bf16 v[16:19], v[28:31], v[100:103], v[16:19]
    s_waitcnt lgkmcnt(5)
    v_and_b32 v28, v41, v8
    v_and_b32 v29, v41, v9
    v_and_b32 v30, v41, v10
    v_and_b32 v31, v41, v11
    s_nop 1
    v_mfma_f32_16x16x32_bf16 v[16:19], v[28:31], v[104:107], v[16:19]
    s_waitcnt lgkmcnt(4)
    v_and_b32 v28, v42, v8
    v_and_b32 v29, v42, v9
    v_and_b32 v30, v42, v10
    v_and_b32 v31, v42, v11
    s_nop 1
    v_mfma_f32_16x16x32_bf16 v[16:19], v[28:31], v[108:111], v[16:19]
    s_waitcnt lgkmcnt(3)
    v_and_b32 v28, v43, v8
    v_and_b32 v29, v43, v9
    v_and_b32 v30, v43, v10
    v_and_b32 v31, v43, v11
    s_nop 1
    v_mfma_f32_16x16x32_bf16 v[16:19], v[28:31], v[112:115], v[16:19]
    s_waitcnt lgkmcnt(2)
    v_and_b32 v28, v44, v8
    v_and_b32 v29, v44, v9
    v_and_b32 v30, v44, v10
    v_and_b32 v31, v44, v11
    s_nop 1
    v_mfma_f32_16x16x32_bf16 v[16:19], v[28:31], v[116:119], v[16:19]
    s_waitcnt lgkmcnt(1)
    v_and_b32 v28, v45, v8
    v_and_b32 v29, v45, v9
    v_and_b32 v30, v45, v10
    v_and_b32 v31, v45, v11
    s_nop 1
    v_mfma_f32_16x16x32_bf16 v[16:19], v[28:31], v[120:123], v[16:19]
    s_waitcnt lgkmcnt(0)
    v_and_b32 v28, v46, v8
    v_and_b32 v29, v46, v9
    v_and_b32 v30, v46, v10
    v_and_b32 v31, v46, v11
    s_nop 1
    v_mfma_f32_16x16x32_bf16 v[16:19], v[28:31], v[124:127], v[16:19]
    ds_read_b32 v37, v36 offset:2560
    ds_read_b32 v38, v36 offset:2592
    ds_read_b32 v39, v36 offset:2624
    ds_read_b32 v40, v36 offset:2656
    ds_read_b32 v41, v36 offset:2688
    ds_read_b32 v42, v36 offset:2720
    ds_read_b32 v43, v36 offset:2752
    ds_read_b32 v44, v36 offset:2784
    ds_read_b32 v45, v36 offset:2816
    ds_read_b32 v46, v36 offset:2848
    s_waitcnt lgkmcnt(9)
    v_and_b32 v28, v37, v8
    v_and_b32 v29, v37, v9
    v_and_b32 v30, v37, v10
    v_and_b32 v31, v37, v11
    s_nop 1
    v_mfma_f32_16x16x32_bf16 v[20:23], v[28:31], v[48:51], v[20:23]
    s_waitcnt lgkmcnt(8)
    v_and_b32 v28, v38, v8
    v_and_b32 v29, v38, v9
    v_and_b32 v30, v38, v10
    v_and_b32 v31, v38, v11
    s_nop 1
    v_mfma_f32_16x16x32_bf16 v[20:23], v[28:31], v[52:55], v[20:23]
    s_waitcnt lgkmcnt(7)
    v_and_b32 v28, v39, v8
    v_and_b32 v29, v39, v9
    v_and_b32 v30, v39, v10
    v_and_b32 v31, v39, v11
    s_nop 1
    v_mfma_f32_16x16x32_bf16 v[20:23], v[28:31], v[56:59], v[20:23]
    s_waitcnt lgkmcnt(6)
    v_and_b32 v28, v40, v8
    v_and_b32 v29, v40, v9
    v_and_b32 v30, v40, v10
    v_and_b32 v31, v40, v11
    s_nop 1
    v_mfma_f32_16x16x32_bf16 v[20:23], v[28:31], v[60:63], v[20:23]
    s_waitcnt lgkmcnt(5)
    v_and_b32 v28, v41, v8
    v_and_b32 v29, v41, v9
    v_and_b32 v30, v41, v10
    v_and_b32 v31, v41, v11
    s_nop 1
    v_mfma_f32_16x16x32_bf16 v[20:23], v[28:31], v[64:67], v[20:23]
    s_waitcnt lgkmcnt(4)
    v_and_b32 v28, v42, v8
    v_and_b32 v29, v42, v9
    v_and_b32 v30, v42, v10
    v_and_b32 v31, v42, v11
    s_nop 1
    v_mfma_f32_16x16x32_bf16 v[20:23], v[28:31], v[68:71], v[20:23]
    s_waitcnt lgkmcnt(3)
    v_and_b32 v28, v43, v8
    v_and_b32 v29, v43, v9
    v_and_b32 v30, v43, v10
    v_and_b32 v31, v43, v11
    s_nop 1
    v_mfma_f32_16x16x32_bf16 v[20:23], v[28:31], v[72:75], v[20:23]
    s_waitcnt lgkmcnt(2)
    v_and_b32 v28, v44, v8
    v_and_b32 v29, v44, v9
    v_and_b32 v30, v44, v10
    v_and_b32 v31, v44, v11
    s_nop 1
    v_mfma_f32_16x16x32_bf16 v[20:23], v[28:31], v[76:79], v[20:23]
    s_waitcnt lgkmcnt(1)
    v_and_b32 v28, v45, v8
    v_and_b32 v29, v45, v9
    v_and_b32 v30, v45, v10
    v_and_b32 v31, v45, v11
    s_nop 1
    v_mfma_f32_16x16x32_bf16 v[20:23], v[28:31], v[80:83], v[20:23]
    s_waitcnt lgkmcnt(0)
    v_and_b32 v28, v46, v8
    v_and_b32 v29, v46, v9
    v_and_b32 v30, v46, v10
    v_and_b32 v31, v46, v11
    s_nop 1
    v_mfma_f32_16x16x32_bf16 v[20:23], v[28:31], v[84:87], v[20:23]
    ds_read_b32 v37, v36 offset:2880
    ds_read_b32 v38, v36 offset:2912
    ds_read_b32 v39, v36 offset:2944
    ds_read_b32 v40, v36 offset:2976
    ds_read_b32 v41, v36 offset:3008
    ds_read_b32 v42, v36 offset:3040
    ds_read_b32 v43, v36 offset:3072
    ds_read_b32 v44, v36 offset:3104
    ds_read_b32 v45, v36 offset:3136
    ds_read_b32 v46, v36 offset:3168
    s_waitcnt lgkmcnt(9)
    v_and_b32 v28, v37, v8
    v_and_b32 v29, v37, v9
    v_and_b32 v30, v37, v10
    v_and_b32 v31, v37, v11
    s_nop 1
    v_mfma_f32_16x16x32_bf16 v[20:23], v[28:31], v[88:91], v[20:23]
    s_waitcnt lgkmcnt(8)
    v_and_b32 v28, v38, v8
    v_and_b32 v29, v38, v9
    v_and_b32 v30, v38, v10
    v_and_b32 v31, v38, v11
    s_nop 1
    v_mfma_f32_16x16x32_bf16 v[20:23], v[28:31], v[92:95], v[20:23]
    s_waitcnt lgkmcnt(7)
    v_and_b32 v28, v39, v8
    v_and_b32 v29, v39, v9
    v_and_b32 v30, v39, v10
    v_and_b32 v31, v39, v11
    s_nop 1
    v_mfma_f32_16x16x32_bf16 v[20:23], v[28:31], v[96:99], v[20:23]
    s_waitcnt lgkmcnt(6)
    v_and_b32 v28, v40, v8
    v_and_b32 v29, v40, v9
    v_and_b32 v30, v40, v10
    v_and_b32 v31, v40, v11
    s_nop 1
    v_mfma_f32_16x16x32_bf16 v[20:23], v[28:31], v[100:103], v[20:23]
    s_waitcnt lgkmcnt(5)
    v_and_b32 v28, v41, v8
    v_and_b32 v29, v41, v9
    v_and_b32 v30, v41, v10
    v_and_b32 v31, v41, v11
    s_nop 1
    v_mfma_f32_16x16x32_bf16 v[20:23], v[28:31], v[104:107], v[20:23]
    s_waitcnt lgkmcnt(4)
    v_and_b32 v28, v42, v8
    v_and_b32 v29, v42, v9
    v_and_b32 v30, v42, v10
    v_and_b32 v31, v42, v11
    s_nop 1
    v_mfma_f32_16x16x32_bf16 v[20:23], v[28:31], v[108:111], v[20:23]
    s_waitcnt lgkmcnt(3)
    v_and_b32 v28, v43, v8
    v_and_b32 v29, v43, v9
    v_and_b32 v30, v43, v10
    v_and_b32 v31, v43, v11
    s_nop 1
    v_mfma_f32_16x16x32_bf16 v[20:23], v[28:31], v[112:115], v[20:23]
    s_waitcnt lgkmcnt(2)
    v_and_b32 v28, v44, v8
    v_and_b32 v29, v44, v9
    v_and_b32 v30, v44, v10
    v_and_b32 v31, v44, v11
    s_nop 1
    v_mfma_f32_16x16x32_bf16 v[20:23], v[28:31], v[116:119], v[20:23]
    s_waitcnt lgkmcnt(1)
    v_and_b32 v28, v45, v8
    v_and_b32 v29, v45, v9
    v_and_b32 v30, v45, v10
    v_and_b32 v31, v45, v11
    s_nop 1
    v_mfma_f32_16x16x32_bf16 v[20:23], v[28:31], v[120:123], v[20:23]
    s_waitcnt lgkmcnt(0)
    v_and_b32 v28, v46, v8
    v_and_b32 v29, v46, v9
    v_and_b32 v30, v46, v10
    v_and_b32 v31, v46, v11
    s_nop 1
    v_mfma_f32_16x16x32_bf16 v[20:23], v[28:31], v[124:127], v[20:23]
    ds_read_b32 v37, v36 offset:5120
    ds_read_b32 v38, v36 offset:5152
    ds_read_b32 v39, v36 offset:5184
    ds_read_b32 v40, v36 offset:5216
    ds_read_b32 v41, v36 offset:5248
    ds_read_b32 v42, v36 offset:5280
    ds_read_b32 v43, v36 offset:5312
    ds_read_b32 v44, v36 offset:5344
    ds_read_b32 v45, v36 offset:5376
    ds_read_b32 v46, v36 offset:5408
    s_waitcnt lgkmcnt(9)
    v_and_b32 v28, v37, v8
    v_and_b32 v29, v37, v9
    v_and_b32 v30, v37, v10
    v_and_b32 v31, v37, v11
    s_nop 1
    v_mfma_f32_16x16x32_bf16 v[24:27], v[28:31], v[48:51], v[24:27]
    s_waitcnt lgkmcnt(8)
    v_and_b32 v28, v38, v8
    v_and_b32 v29, v38, v9
    v_and_b32 v30, v38, v10
    v_and_b32 v31, v38, v11
    s_nop 1
    v_mfma_f32_16x16x32_bf16 v[24:27], v[28:31], v[52:55], v[24:27]
    s_waitcnt lgkmcnt(7)
    v_and_b32 v28, v39, v8
    v_and_b32 v29, v39, v9
    v_and_b32 v30, v39, v10
    v_and_b32 v31, v39, v11
    s_nop 1
    v_mfma_f32_16x16x32_bf16 v[24:27], v[28:31], v[56:59], v[24:27]
    s_waitcnt lgkmcnt(6)
    v_and_b32 v28, v40, v8
    v_and_b32 v29, v40, v9
    v_and_b32 v30, v40, v10
    v_and_b32 v31, v40, v11
    s_nop 1
    v_mfma_f32_16x16x32_bf16 v[24:27], v[28:31], v[60:63], v[24:27]
    s_waitcnt lgkmcnt(5)
    v_and_b32 v28, v41, v8
    v_and_b32 v29, v41, v9
    v_and_b32 v30, v41, v10
    v_and_b32 v31, v41, v11
    s_nop 1
    v_mfma_f32_16x16x32_bf16 v[24:27], v[28:31], v[64:67], v[24:27]
    s_waitcnt lgkmcnt(4)
    v_and_b32 v28, v42, v8
    v_and_b32 v29, v42, v9
    v_and_b32 v30, v42, v10
    v_and_b32 v31, v42, v11
    s_nop 1
    v_mfma_f32_16x16x32_bf16 v[24:27], v[28:31], v[68:71], v[24:27]
    s_waitcnt lgkmcnt(3)
    v_and_b32 v28, v43, v8
    v_and_b32 v29, v43, v9
    v_and_b32 v30, v43, v10
    v_and_b32 v31, v43, v11
    s_nop 1
    v_mfma_f32_16x16x32_bf16 v[24:27], v[28:31], v[72:75], v[24:27]
    s_waitcnt lgkmcnt(2)
    v_and_b32 v28, v44, v8
    v_and_b32 v29, v44, v9
    v_and_b32 v30, v44, v10
    v_and_b32 v31, v44, v11
    s_nop 1
    v_mfma_f32_16x16x32_bf16 v[24:27], v[28:31], v[76:79], v[24:27]
    s_waitcnt lgkmcnt(1)
    v_and_b32 v28, v45, v8
    v_and_b32 v29, v45, v9
    v_and_b32 v30, v45, v10
    v_and_b32 v31, v45, v11
    s_nop 1
    v_mfma_f32_16x16x32_bf16 v[24:27], v[28:31], v[80:83], v[24:27]
    s_waitcnt lgkmcnt(0)
    v_and_b32 v28, v46, v8
    v_and_b32 v29, v46, v9
    v_and_b32 v30, v46, v10
    v_and_b32 v31, v46, v11
    s_nop 1
    v_mfma_f32_16x16x32_bf16 v[24:27], v[28:31], v[84:87], v[24:27]
    ds_read_b32 v37, v36 offset:5440
    ds_read_b32 v38, v36 offset:5472
    ds_read_b32 v39, v36 offset:5504
    ds_read_b32 v40, v36 offset:5536
    ds_read_b32 v41, v36 offset:5568
    ds_read_b32 v42, v36 offset:5600
    ds_read_b32 v43, v36 offset:5632
    ds_read_b32 v44, v36 offset:5664
    ds_read_b32 v45, v36 offset:5696
    ds_read_b32 v46, v36 offset:5728
    s_waitcnt lgkmcnt(9)
    v_and_b32 v28, v37, v8
    v_and_b32 v29, v37, v9
    v_and_b32 v30, v37, v10
    v_and_b32 v31, v37, v11
    s_nop 1
    v_mfma_f32_16x16x32_bf16 v[24:27], v[28:31], v[88:91], v[24:27]
    s_waitcnt lgkmcnt(8)
    v_and_b32 v28, v38, v8
    v_and_b32 v29, v38, v9
    v_and_b32 v30, v38, v10
    v_and_b32 v31, v38, v11
    s_nop 1
    v_mfma_f32_16x16x32_bf16 v[24:27], v[28:31], v[92:95], v[24:27]
    s_waitcnt lgkmcnt(7)
    v_and_b32 v28, v39, v8
    v_and_b32 v29, v39, v9
    v_and_b32 v30, v39, v10
    v_and_b32 v31, v39, v11
    s_nop 1
    v_mfma_f32_16x16x32_bf16 v[24:27], v[28:31], v[96:99], v[24:27]
    s_waitcnt lgkmcnt(6)
    v_and_b32 v28, v40, v8
    v_and_b32 v29, v40, v9
    v_and_b32 v30, v40, v10
    v_and_b32 v31, v40, v11
    s_nop 1
    v_mfma_f32_16x16x32_bf16 v[24:27], v[28:31], v[100:103], v[24:27]
    s_waitcnt lgkmcnt(5)
    v_and_b32 v28, v41, v8
    v_and_b32 v29, v41, v9
    v_and_b32 v30, v41, v10
    v_and_b32 v31, v41, v11
    s_nop 1
    v_mfma_f32_16x16x32_bf16 v[24:27], v[28:31], v[104:107], v[24:27]
    s_waitcnt lgkmcnt(4)
    v_and_b32 v28, v42, v8
    v_and_b32 v29, v42, v9
    v_and_b32 v30, v42, v10
    v_and_b32 v31, v42, v11
    s_nop 1
    v_mfma_f32_16x16x32_bf16 v[24:27], v[28:31], v[108:111], v[24:27]
    s_waitcnt lgkmcnt(3)
    v_and_b32 v28, v43, v8
    v_and_b32 v29, v43, v9
    v_and_b32 v30, v43, v10
    v_and_b32 v31, v43, v11
    s_nop 1
    v_mfma_f32_16x16x32_bf16 v[24:27], v[28:31], v[112:115], v[24:27]
    s_waitcnt lgkmcnt(2)
    v_and_b32 v28, v44, v8
    v_and_b32 v29, v44, v9
    v_and_b32 v30, v44, v10
    v_and_b32 v31, v44, v11
    s_nop 1
    v_mfma_f32_16x16x32_bf16 v[24:27], v[28:31], v[116:119], v[24:27]
    s_waitcnt lgkmcnt(1)
    v_and_b32 v28, v45, v8
    v_and_b32 v29, v45, v9
    v_and_b32 v30, v45, v10
    v_and_b32 v31, v45, v11
    s_nop 1
    v_mfma_f32_16x16x32_bf16 v[24:27], v[28:31], v[120:123], v[24:27]
    s_waitcnt lgkmcnt(0)
    v_and_b32 v28, v46, v8
    v_and_b32 v29, v46, v9
    v_and_b32 v30, v46, v10
    v_and_b32 v31, v46, v11
    s_nop 1
    v_mfma_f32_16x16x32_bf16 v[24:27], v[28:31], v[124:127], v[24:27]
    ds_read_b32 v37, v36 offset:7680
    ds_read_b32 v38, v36 offset:7712
    ds_read_b32 v39, v36 offset:7744
    ds_read_b32 v40, v36 offset:7776
    ds_read_b32 v41, v36 offset:7808
    ds_read_b32 v42, v36 offset:7840
    ds_read_b32 v43, v36 offset:7872
    ds_read_b32 v44, v36 offset:7904
    ds_read_b32 v45, v36 offset:7936
    ds_read_b32 v46, v36 offset:7968
    s_waitcnt lgkmcnt(9)
    v_and_b32 v28, v37, v8
    v_and_b32 v29, v37, v9
    v_and_b32 v30, v37, v10
    v_and_b32 v31, v37, v11
    s_nop 1
    v_mfma_f32_16x16x32_bf16 v[32:35], v[28:31], v[48:51], v[32:35]
    s_waitcnt lgkmcnt(8)
    v_and_b32 v28, v38, v8
    v_and_b32 v29, v38, v9
    v_and_b32 v30, v38, v10
    v_and_b32 v31, v38, v11
    s_nop 1
    v_mfma_f32_16x16x32_bf16 v[32:35], v[28:31], v[52:55], v[32:35]
    s_waitcnt lgkmcnt(7)
    v_and_b32 v28, v39, v8
    v_and_b32 v29, v39, v9
    v_and_b32 v30, v39, v10
    v_and_b32 v31, v39, v11
    s_nop 1
    v_mfma_f32_16x16x32_bf16 v[32:35], v[28:31], v[56:59], v[32:35]
    s_waitcnt lgkmcnt(6)
    v_and_b32 v28, v40, v8
    v_and_b32 v29, v40, v9
    v_and_b32 v30, v40, v10
    v_and_b32 v31, v40, v11
    s_nop 1
    v_mfma_f32_16x16x32_bf16 v[32:35], v[28:31], v[60:63], v[32:35]
    s_waitcnt lgkmcnt(5)
    v_and_b32 v28, v41, v8
    v_and_b32 v29, v41, v9
    v_and_b32 v30, v41, v10
    v_and_b32 v31, v41, v11
    s_nop 1
    v_mfma_f32_16x16x32_bf16 v[32:35], v[28:31], v[64:67], v[32:35]
    s_waitcnt lgkmcnt(4)
    v_and_b32 v28, v42, v8
    v_and_b32 v29, v42, v9
    v_and_b32 v30, v42, v10
    v_and_b32 v31, v42, v11
    s_nop 1
    v_mfma_f32_16x16x32_bf16 v[32:35], v[28:31], v[68:71], v[32:35]
    s_waitcnt lgkmcnt(3)
    v_and_b32 v28, v43, v8
    v_and_b32 v29, v43, v9
    v_and_b32 v30, v43, v10
    v_and_b32 v31, v43, v11
    s_nop 1
    v_mfma_f32_16x16x32_bf16 v[32:35], v[28:31], v[72:75], v[32:35]
    s_waitcnt lgkmcnt(2)
    v_and_b32 v28, v44, v8
    v_and_b32 v29, v44, v9
    v_and_b32 v30, v44, v10
    v_and_b32 v31, v44, v11
    s_nop 1
    v_mfma_f32_16x16x32_bf16 v[32:35], v[28:31], v[76:79], v[32:35]
    s_waitcnt lgkmcnt(1)
    v_and_b32 v28, v45, v8
    v_and_b32 v29, v45, v9
    v_and_b32 v30, v45, v10
    v_and_b32 v31, v45, v11
    s_nop 1
    v_mfma_f32_16x16x32_bf16 v[32:35], v[28:31], v[80:83], v[32:35]
    s_waitcnt lgkmcnt(0)
    v_and_b32 v28, v46, v8
    v_and_b32 v29, v46, v9
    v_and_b32 v30, v46, v10
    v_and_b32 v31, v46, v11
    s_nop 1
    v_mfma_f32_16x16x32_bf16 v[32:35], v[28:31], v[84:87], v[32:35]
    ds_read_b32 v37, v36 offset:8000
    ds_read_b32 v38, v36 offset:8032
    ds_read_b32 v39, v36 offset:8064
    ds_read_b32 v40, v36 offset:8096
    ds_read_b32 v41, v36 offset:8128
    ds_read_b32 v42, v36 offset:8160
    ds_read_b32 v43, v36 offset:8192
    ds_read_b32 v44, v36 offset:8224
    ds_read_b32 v45, v36 offset:8256
    ds_read_b32 v46, v36 offset:8288
    s_waitcnt lgkmcnt(9)
    v_and_b32 v28, v37, v8
    v_and_b32 v29, v37, v9
    v_and_b32 v30, v37, v10
    v_and_b32 v31, v37, v11
    s_nop 1
    v_mfma_f32_16x16x32_bf16 v[32:35], v[28:31], v[88:91], v[32:35]
    s_waitcnt lgkmcnt(8)
    v_and_b32 v28, v38, v8
    v_and_b32 v29, v38, v9
    v_and_b32 v30, v38, v10
    v_and_b32 v31, v38, v11
    s_nop 1
    v_mfma_f32_16x16x32_bf16 v[32:35], v[28:31], v[92:95], v[32:35]
    s_waitcnt lgkmcnt(7)
    v_and_b32 v28, v39, v8
    v_and_b32 v29, v39, v9
    v_and_b32 v30, v39, v10
    v_and_b32 v31, v39, v11
    s_nop 1
    v_mfma_f32_16x16x32_bf16 v[32:35], v[28:31], v[96:99], v[32:35]
    s_waitcnt lgkmcnt(6)
    v_and_b32 v28, v40, v8
    v_and_b32 v29, v40, v9
    v_and_b32 v30, v40, v10
    v_and_b32 v31, v40, v11
    s_nop 1
    v_mfma_f32_16x16x32_bf16 v[32:35], v[28:31], v[100:103], v[32:35]
    s_waitcnt lgkmcnt(5)
    v_and_b32 v28, v41, v8
    v_and_b32 v29, v41, v9
    v_and_b32 v30, v41, v10
    v_and_b32 v31, v41, v11
    s_nop 1
    v_mfma_f32_16x16x32_bf16 v[32:35], v[28:31], v[104:107], v[32:35]
    s_waitcnt lgkmcnt(4)
    v_and_b32 v28, v42, v8
    v_and_b32 v29, v42, v9
    v_and_b32 v30, v42, v10
    v_and_b32 v31, v42, v11
    s_nop 1
    v_mfma_f32_16x16x32_bf16 v[32:35], v[28:31], v[108:111], v[32:35]
    s_waitcnt lgkmcnt(3)
    v_and_b32 v28, v43, v8
    v_and_b32 v29, v43, v9
    v_and_b32 v30, v43, v10
    v_and_b32 v31, v43, v11
    s_nop 1
    v_mfma_f32_16x16x32_bf16 v[32:35], v[28:31], v[112:115], v[32:35]
    s_waitcnt lgkmcnt(2)
    v_and_b32 v28, v44, v8
    v_and_b32 v29, v44, v9
    v_and_b32 v30, v44, v10
    v_and_b32 v31, v44, v11
    s_nop 1
    v_mfma_f32_16x16x32_bf16 v[32:35], v[28:31], v[116:119], v[32:35]
    s_waitcnt lgkmcnt(1)
    v_and_b32 v28, v45, v8
    v_and_b32 v29, v45, v9
    v_and_b32 v30, v45, v10
    v_and_b32 v31, v45, v11
    s_nop 1
    v_mfma_f32_16x16x32_bf16 v[32:35], v[28:31], v[120:123], v[32:35]
    s_waitcnt lgkmcnt(0)
    v_and_b32 v28, v46, v8
    v_and_b32 v29, v46, v9
    v_and_b32 v30, v46, v10
    v_and_b32 v31, v46, v11
    s_nop 1
    v_mfma_f32_16x16x32_bf16 v[32:35], v[28:31], v[124:127], v[32:35]
    s_nop 7
    v_permlane32_swap_b32 v16, v24
    v_permlane32_swap_b32 v17, v25
    v_permlane32_swap_b32 v18, v26
    v_permlane32_swap_b32 v19, v27
    v_permlane32_swap_b32 v20, v32
    v_permlane32_swap_b32 v21, v33
    v_permlane32_swap_b32 v22, v34
    v_permlane32_swap_b32 v23, v35
    s_nop 1
    v_add_f32_dpp v16, v24, v16 row_ror:8 row_mask:0xf bank_mask:0xf
    v_add_f32_dpp v17, v25, v17 row_ror:8 row_mask:0xf bank_mask:0xf
    v_add_f32_dpp v18, v26, v18 row_ror:8 row_mask:0xf bank_mask:0xf
    v_add_f32_dpp v19, v27, v19 row_ror:8 row_mask:0xf bank_mask:0xf
    v_add_f32_dpp v20, v32, v20 row_ror:8 row_mask:0xf bank_mask:0xf
    v_add_f32_dpp v21, v33, v21 row_ror:8 row_mask:0xf bank_mask:0xf
    v_add_f32_dpp v22, v34, v22 row_ror:8 row_mask:0xf bank_mask:0xf
    v_add_f32_dpp v23, v35, v23 row_ror:8 row_mask:0xf bank_mask:0xf
    s_mov_b32 exec_lo, 0x00ff00ff
    s_mov_b32 exec_hi, 0x00ff00ff
    ds_write_b128 v47, v[16:19] offset:0
    ds_write_b128 v47, v[20:23] offset:256
    s_mov_b64 exec, -1
    s_nop 1
    v_mov_b32 v16, 0
    v_mov_b32 v17, 0
    v_mov_b32 v18, 0
    v_mov_b32 v19, 0
    v_mov_b32 v20, 0
    v_mov_b32 v21, 0
    v_mov_b32 v22, 0
    v_mov_b32 v23, 0
    v_mov_b32 v24, 0
    v_mov_b32 v25, 0
    v_mov_b32 v26, 0
    v_mov_b32 v27, 0
    v_mov_b32 v32, 0
    v_mov_b32 v33, 0
    v_mov_b32 v34, 0
    v_mov_b32 v35, 0
    ds_read_b32 v37, v36 offset:10240
    ds_read_b32 v38, v36 offset:10272
    ds_read_b32 v39, v36 offset:10304
    ds_read_b32 v40, v36 offset:10336
    ds_read_b32 v41, v36 offset:10368
    ds_read_b32 v42, v36 offset:10400
    ds_read_b32 v43, v36 offset:10432
    ds_read_b32 v44, v36 offset:10464
    ds_read_b32 v45, v36 offset:10496
    ds_read_b32 v46, v36 offset:10528
    s_waitcnt lgkmcnt(9)
    v_and_b32 v28, v37, v8
    v_and_b32 v29, v37, v9
    v_and_b32 v30, v37, v10
    v_and_b32 v31, v37, v11
    s_nop 1
    v_mfma_f32_16x16x32_bf16 v[16:19], v[28:31], v[48:51], v[16:19]
    s_waitcnt lgkmcnt(8)
    v_and_b32 v28, v38, v8
    v_and_b32 v29, v38, v9
    v_and_b32 v30, v38, v10
    v_and_b32 v31, v38, v11
    s_nop 1
    v_mfma_f32_16x16x32_bf16 v[16:19], v[28:31], v[52:55], v[16:19]
    s_waitcnt lgkmcnt(7)
    v_and_b32 v28, v39, v8
    v_and_b32 v29, v39, v9
    v_and_b32 v30, v39, v10
    v_and_b32 v31, v39, v11
    s_nop 1
    v_mfma_f32_16x16x32_bf16 v[16:19], v[28:31], v[56:59], v[16:19]
    s_waitcnt lgkmcnt(6)
    v_and_b32 v28, v40, v8
    v_and_b32 v29, v40, v9
    v_and_b32 v30, v40, v10
    v_and_b32 v31, v40, v11
    s_nop 1
    v_mfma_f32_16x16x32_bf16 v[16:19], v[28:31], v[60:63], v[16:19]
    s_waitcnt lgkmcnt(5)
    v_and_b32 v28, v41, v8
    v_and_b32 v29, v41, v9
    v_and_b32 v30, v41, v10
    v_and_b32 v31, v41, v11
    s_nop 1
    v_mfma_f32_16x16x32_bf16 v[16:19], v[28:31], v[64:67], v[16:19]
    s_waitcnt lgkmcnt(4)
    v_and_b32 v28, v42, v8
    v_and_b32 v29, v42, v9
    v_and_b32 v30, v42, v10
    v_and_b32 v31, v42, v11
    s_nop 1
    v_mfma_f32_16x16x32_bf16 v[16:19], v[28:31], v[68:71], v[16:19]
    s_waitcnt lgkmcnt(3)
    v_and_b32 v28, v43, v8
    v_and_b32 v29, v43, v9
    v_and_b32 v30, v43, v10
    v_and_b32 v31, v43, v11
    s_nop 1
    v_mfma_f32_16x16x32_bf16 v[16:19], v[28:31], v[72:75], v[16:19]
    s_waitcnt lgkmcnt(2)
    v_and_b32 v28, v44, v8
    v_and_b32 v29, v44, v9
    v_and_b32 v30, v44, v10
    v_and_b32 v31, v44, v11
    s_nop 1
    v_mfma_f32_16x16x32_bf16 v[16:19], v[28:31], v[76:79], v[16:19]
    s_waitcnt lgkmcnt(1)
    v_and_b32 v28, v45, v8
    v_and_b32 v29, v45, v9
    v_and_b32 v30, v45, v10
    v_and_b32 v31, v45, v11
    s_nop 1
    v_mfma_f32_16x16x32_bf16 v[16:19], v[28:31], v[80:83], v[16:19]
    s_waitcnt lgkmcnt(0)
    v_and_b32 v28, v46, v8
    v_and_b32 v29, v46, v9
    v_and_b32 v30, v46, v10
    v_and_b32 v31, v46, v11
    s_nop 1
    v_mfma_f32_16x16x32_bf16 v[16:19], v[28:31], v[84:87], v[16:19]
    ds_read_b32 v37, v36 offset:10560
    ds_read_b32 v38, v36 offset:10592
    ds_read_b32 v39, v36 offset:10624
    ds_read_b32 v40, v36 offset:10656
    ds_read_b32 v41, v36 offset:10688
    ds_read_b32 v42, v36 offset:10720
    ds_read_b32 v43, v36 offset:10752
    ds_read_b32 v44, v36 offset:10784
    ds_read_b32 v45, v36 offset:10816
    ds_read_b32 v46, v36 offset:10848
    s_waitcnt lgkmcnt(9)
    v_and_b32 v28, v37, v8
    v_and_b32 v29, v37, v9
    v_and_b32 v30, v37, v10
    v_and_b32 v31, v37, v11
    s_nop 1
    v_mfma_f32_16x16x32_bf16 v[16:19], v[28:31], v[88:91], v[16:19]
    s_waitcnt lgkmcnt(8)
    v_and_b32 v28, v38, v8
    v_and_b32 v29, v38, v9
    v_and_b32 v30, v38, v10
    v_and_b32 v31, v38, v11
    s_nop 1
    v_mfma_f32_16x16x32_bf16 v[16:19], v[28:31], v[92:95], v[16:19]
    s_waitcnt lgkmcnt(7)
    v_and_b32 v28, v39, v8
    v_and_b32 v29, v39, v9
    v_and_b32 v30, v39, v10
    v_and_b32 v31, v39, v11
    s_nop 1
    v_mfma_f32_16x16x32_bf16 v[16:19], v[28:31], v[96:99], v[16:19]
    s_waitcnt lgkmcnt(6)
    v_and_b32 v28, v40, v8
    v_and_b32 v29, v40, v9
    v_and_b32 v30, v40, v10
    v_and_b32 v31, v40, v11
    s_nop 1
    v_mfma_f32_16x16x32_bf16 v[16:19], v[28:31], v[100:103], v[16:19]
    s_waitcnt lgkmcnt(5)
    v_and_b32 v28, v41, v8
    v_and_b32 v29, v41, v9
    v_and_b32 v30, v41, v10
    v_and_b32 v31, v41, v11
    s_nop 1
    v_mfma_f32_16x16x32_bf16 v[16:19], v[28:31], v[104:107], v[16:19]
    s_waitcnt lgkmcnt(4)
    v_and_b32 v28, v42, v8
    v_and_b32 v29, v42, v9
    v_and_b32 v30, v42, v10
    v_and_b32 v31, v42, v11
    s_nop 1
    v_mfma_f32_16x16x32_bf16 v[16:19], v[28:31], v[108:111], v[16:19]
    s_waitcnt lgkmcnt(3)
    v_and_b32 v28, v43, v8
    v_and_b32 v29, v43, v9
    v_and_b32 v30, v43, v10
    v_and_b32 v31, v43, v11
    s_nop 1
    v_mfma_f32_16x16x32_bf16 v[16:19], v[28:31], v[112:115], v[16:19]
    s_waitcnt lgkmcnt(2)
    v_and_b32 v28, v44, v8
    v_and_b32 v29, v44, v9
    v_and_b32 v30, v44, v10
    v_and_b32 v31, v44, v11
    s_nop 1
    v_mfma_f32_16x16x32_bf16 v[16:19], v[28:31], v[116:119], v[16:19]
    s_waitcnt lgkmcnt(1)
    v_and_b32 v28, v45, v8
    v_and_b32 v29, v45, v9
    v_and_b32 v30, v45, v10
    v_and_b32 v31, v45, v11
    s_nop 1
    v_mfma_f32_16x16x32_bf16 v[16:19], v[28:31], v[120:123], v[16:19]
    s_waitcnt lgkmcnt(0)
    v_and_b32 v28, v46, v8
    v_and_b32 v29, v46, v9
    v_and_b32 v30, v46, v10
    v_and_b32 v31, v46, v11
    s_nop 1
    v_mfma_f32_16x16x32_bf16 v[16:19], v[28:31], v[124:127], v[16:19]
    ds_read_b32 v37, v36 offset:12800
    ds_read_b32 v38, v36 offset:12832
    ds_read_b32 v39, v36 offset:12864
    ds_read_b32 v40, v36 offset:12896
    ds_read_b32 v41, v36 offset:12928
    ds_read_b32 v42, v36 offset:12960
    ds_read_b32 v43, v36 offset:12992
    ds_read_b32 v44, v36 offset:13024
    ds_read_b32 v45, v36 offset:13056
    ds_read_b32 v46, v36 offset:13088
    s_waitcnt lgkmcnt(9)
    v_and_b32 v28, v37, v8
    v_and_b32 v29, v37, v9
    v_and_b32 v30, v37, v10
    v_and_b32 v31, v37, v11
    s_nop 1
    v_mfma_f32_16x16x32_bf16 v[20:23], v[28:31], v[48:51], v[20:23]
    s_waitcnt lgkmcnt(8)
    v_and_b32 v28, v38, v8
    v_and_b32 v29, v38, v9
    v_and_b32 v30, v38, v10
    v_and_b32 v31, v38, v11
    s_nop 1
    v_mfma_f32_16x16x32_bf16 v[20:23], v[28:31], v[52:55], v[20:23]
    s_waitcnt lgkmcnt(7)
    v_and_b32 v28, v39, v8
    v_and_b32 v29, v39, v9
    v_and_b32 v30, v39, v10
    v_and_b32 v31, v39, v11
    s_nop 1
    v_mfma_f32_16x16x32_bf16 v[20:23], v[28:31], v[56:59], v[20:23]
    s_waitcnt lgkmcnt(6)
    v_and_b32 v28, v40, v8
    v_and_b32 v29, v40, v9
    v_and_b32 v30, v40, v10
    v_and_b32 v31, v40, v11
    s_nop 1
    v_mfma_f32_16x16x32_bf16 v[20:23], v[28:31], v[60:63], v[20:23]
    s_waitcnt lgkmcnt(5)
    v_and_b32 v28, v41, v8
    v_and_b32 v29, v41, v9
    v_and_b32 v30, v41, v10
    v_and_b32 v31, v41, v11
    s_nop 1
    v_mfma_f32_16x16x32_bf16 v[20:23], v[28:31], v[64:67], v[20:23]
    s_waitcnt lgkmcnt(4)
    v_and_b32 v28, v42, v8
    v_and_b32 v29, v42, v9
    v_and_b32 v30, v42, v10
    v_and_b32 v31, v42, v11
    s_nop 1
    v_mfma_f32_16x16x32_bf16 v[20:23], v[28:31], v[68:71], v[20:23]
    s_waitcnt lgkmcnt(3)
    v_and_b32 v28, v43, v8
    v_and_b32 v29, v43, v9
    v_and_b32 v30, v43, v10
    v_and_b32 v31, v43, v11
    s_nop 1
    v_mfma_f32_16x16x32_bf16 v[20:23], v[28:31], v[72:75], v[20:23]
    s_waitcnt lgkmcnt(2)
    v_and_b32 v28, v44, v8
    v_and_b32 v29, v44, v9
    v_and_b32 v30, v44, v10
    v_and_b32 v31, v44, v11
    s_nop 1
    v_mfma_f32_16x16x32_bf16 v[20:23], v[28:31], v[76:79], v[20:23]
    s_waitcnt lgkmcnt(1)
    v_and_b32 v28, v45, v8
    v_and_b32 v29, v45, v9
    v_and_b32 v30, v45, v10
    v_and_b32 v31, v45, v11
    s_nop 1
    v_mfma_f32_16x16x32_bf16 v[20:23], v[28:31], v[80:83], v[20:23]
    s_waitcnt lgkmcnt(0)
    v_and_b32 v28, v46, v8
    v_and_b32 v29, v46, v9
    v_and_b32 v30, v46, v10
    v_and_b32 v31, v46, v11
    s_nop 1
    v_mfma_f32_16x16x32_bf16 v[20:23], v[28:31], v[84:87], v[20:23]
    ds_read_b32 v37, v36 offset:13120
    ds_read_b32 v38, v36 offset:13152
    ds_read_b32 v39, v36 offset:13184
    ds_read_b32 v40, v36 offset:13216
    ds_read_b32 v41, v36 offset:13248
    ds_read_b32 v42, v36 offset:13280
    ds_read_b32 v43, v36 offset:13312
    ds_read_b32 v44, v36 offset:13344
    ds_read_b32 v45, v36 offset:13376
    ds_read_b32 v46, v36 offset:13408
    s_waitcnt lgkmcnt(9)
    v_and_b32 v28, v37, v8
    v_and_b32 v29, v37, v9
    v_and_b32 v30, v37, v10
    v_and_b32 v31, v37, v11
    s_nop 1
    v_mfma_f32_16x16x32_bf16 v[20:23], v[28:31], v[88:91], v[20:23]
    s_waitcnt lgkmcnt(8)
    v_and_b32 v28, v38, v8
    v_and_b32 v29, v38, v9
    v_and_b32 v30, v38, v10
    v_and_b32 v31, v38, v11
    s_nop 1
    v_mfma_f32_16x16x32_bf16 v[20:23], v[28:31], v[92:95], v[20:23]
    s_waitcnt lgkmcnt(7)
    v_and_b32 v28, v39, v8
    v_and_b32 v29, v39, v9
    v_and_b32 v30, v39, v10
    v_and_b32 v31, v39, v11
    s_nop 1
    v_mfma_f32_16x16x32_bf16 v[20:23], v[28:31], v[96:99], v[20:23]
    s_waitcnt lgkmcnt(6)
    v_and_b32 v28, v40, v8
    v_and_b32 v29, v40, v9
    v_and_b32 v30, v40, v10
    v_and_b32 v31, v40, v11
    s_nop 1
    v_mfma_f32_16x16x32_bf16 v[20:23], v[28:31], v[100:103], v[20:23]
    s_waitcnt lgkmcnt(5)
    v_and_b32 v28, v41, v8
    v_and_b32 v29, v41, v9
    v_and_b32 v30, v41, v10
    v_and_b32 v31, v41, v11
    s_nop 1
    v_mfma_f32_16x16x32_bf16 v[20:23], v[28:31], v[104:107], v[20:23]
    s_waitcnt lgkmcnt(4)
    v_and_b32 v28, v42, v8
    v_and_b32 v29, v42, v9
    v_and_b32 v30, v42, v10
    v_and_b32 v31, v42, v11
    s_nop 1
    v_mfma_f32_16x16x32_bf16 v[20:23], v[28:31], v[108:111], v[20:23]
    s_waitcnt lgkmcnt(3)
    v_and_b32 v28, v43, v8
    v_and_b32 v29, v43, v9
    v_and_b32 v30, v43, v10
    v_and_b32 v31, v43, v11
    s_nop 1
    v_mfma_f32_16x16x32_bf16 v[20:23], v[28:31], v[112:115], v[20:23]
    s_waitcnt lgkmcnt(2)
    v_and_b32 v28, v44, v8
    v_and_b32 v29, v44, v9
    v_and_b32 v30, v44, v10
    v_and_b32 v31, v44, v11
    s_nop 1
    v_mfma_f32_16x16x32_bf16 v[20:23], v[28:31], v[116:119], v[20:23]
    s_waitcnt lgkmcnt(1)
    v_and_b32 v28, v45, v8
    v_and_b32 v29, v45, v9
    v_and_b32 v30, v45, v10
    v_and_b32 v31, v45, v11
    s_nop 1
    v_mfma_f32_16x16x32_bf16 v[20:23], v[28:31], v[120:123], v[20:23]
    s_waitcnt lgkmcnt(0)
    v_and_b32 v28, v46, v8
    v_and_b32 v29, v46, v9
    v_and_b32 v30, v46, v10
    v_and_b32 v31, v46, v11
    s_nop 1
    v_mfma_f32_16x16x32_bf16 v[20:23], v[28:31], v[124:127], v[20:23]
    ds_read_b32 v37, v36 offset:15360
    ds_read_b32 v38, v36 offset:15392
    ds_read_b32 v39, v36 offset:15424
    ds_read_b32 v40, v36 offset:15456
    ds_read_b32 v41, v36 offset:15488
    ds_read_b32 v42, v36 offset:15520
    ds_read_b32 v43, v36 offset:15552
    ds_read_b32 v44, v36 offset:15584
    ds_read_b32 v45, v36 offset:15616
    ds_read_b32 v46, v36 offset:15648
    s_waitcnt lgkmcnt(9)
    v_and_b32 v28, v37, v8
    v_and_b32 v29, v37, v9
    v_and_b32 v30, v37, v10
    v_and_b32 v31, v37, v11
    s_nop 1
    v_mfma_f32_16x16x32_bf16 v[24:27], v[28:31], v[48:51], v[24:27]
    s_waitcnt lgkmcnt(8)
    v_and_b32 v28, v38, v8
    v_and_b32 v29, v38, v9
    v_and_b32 v30, v38, v10
    v_and_b32 v31, v38, v11
    s_nop 1
    v_mfma_f32_16x16x32_bf16 v[24:27], v[28:31], v[52:55], v[24:27]
    s_waitcnt lgkmcnt(7)
    v_and_b32 v28, v39, v8
    v_and_b32 v29, v39, v9
    v_and_b32 v30, v39, v10
    v_and_b32 v31, v39, v11
    s_nop 1
    v_mfma_f32_16x16x32_bf16 v[24:27], v[28:31], v[56:59], v[24:27]
    s_waitcnt lgkmcnt(6)
    v_and_b32 v28, v40, v8
    v_and_b32 v29, v40, v9
    v_and_b32 v30, v40, v10
    v_and_b32 v31, v40, v11
    s_nop 1
    v_mfma_f32_16x16x32_bf16 v[24:27], v[28:31], v[60:63], v[24:27]
    s_waitcnt lgkmcnt(5)
    v_and_b32 v28, v41, v8
    v_and_b32 v29, v41, v9
    v_and_b32 v30, v41, v10
    v_and_b32 v31, v41, v11
    s_nop 1
    v_mfma_f32_16x16x32_bf16 v[24:27], v[28:31], v[64:67], v[24:27]
    s_waitcnt lgkmcnt(4)
    v_and_b32 v28, v42, v8
    v_and_b32 v29, v42, v9
    v_and_b32 v30, v42, v10
    v_and_b32 v31, v42, v11
    s_nop 1
    v_mfma_f32_16x16x32_bf16 v[24:27], v[28:31], v[68:71], v[24:27]
    s_waitcnt lgkmcnt(3)
    v_and_b32 v28, v43, v8
    v_and_b32 v29, v43, v9
    v_and_b32 v30, v43, v10
    v_and_b32 v31, v43, v11
    s_nop 1
    v_mfma_f32_16x16x32_bf16 v[24:27], v[28:31], v[72:75], v[24:27]
    s_waitcnt lgkmcnt(2)
    v_and_b32 v28, v44, v8
    v_and_b32 v29, v44, v9
    v_and_b32 v30, v44, v10
    v_and_b32 v31, v44, v11
    s_nop 1
    v_mfma_f32_16x16x32_bf16 v[24:27], v[28:31], v[76:79], v[24:27]
    s_waitcnt lgkmcnt(1)
    v_and_b32 v28, v45, v8
    v_and_b32 v29, v45, v9
    v_and_b32 v30, v45, v10
    v_and_b32 v31, v45, v11
    s_nop 1
    v_mfma_f32_16x16x32_bf16 v[24:27], v[28:31], v[80:83], v[24:27]
    s_waitcnt lgkmcnt(0)
    v_and_b32 v28, v46, v8
    v_and_b32 v29, v46, v9
    v_and_b32 v30, v46, v10
    v_and_b32 v31, v46, v11
    s_nop 1
    v_mfma_f32_16x16x32_bf16 v[24:27], v[28:31], v[84:87], v[24:27]
    ds_read_b32 v37, v36 offset:15680
    ds_read_b32 v38, v36 offset:15712
    ds_read_b32 v39, v36 offset:15744
    ds_read_b32 v40, v36 offset:15776
    ds_read_b32 v41, v36 offset:15808
    ds_read_b32 v42, v36 offset:15840
    ds_read_b32 v43, v36 offset:15872
    ds_read_b32 v44, v36 offset:15904
    ds_read_b32 v45, v36 offset:15936
    ds_read_b32 v46, v36 offset:15968
    s_waitcnt lgkmcnt(9)
    v_and_b32 v28, v37, v8
    v_and_b32 v29, v37, v9
    v_and_b32 v30, v37, v10
    v_and_b32 v31, v37, v11
    s_nop 1
    v_mfma_f32_16x16x32_bf16 v[24:27], v[28:31], v[88:91], v[24:27]
    s_waitcnt lgkmcnt(8)
    v_and_b32 v28, v38, v8
    v_and_b32 v29, v38, v9
    v_and_b32 v30, v38, v10
    v_and_b32 v31, v38, v11
    s_nop 1
    v_mfma_f32_16x16x32_bf16 v[24:27], v[28:31], v[92:95], v[24:27]
    s_waitcnt lgkmcnt(7)
    v_and_b32 v28, v39, v8
    v_and_b32 v29, v39, v9
    v_and_b32 v30, v39, v10
    v_and_b32 v31, v39, v11
    s_nop 1
    v_mfma_f32_16x16x32_bf16 v[24:27], v[28:31], v[96:99], v[24:27]
    s_waitcnt lgkmcnt(6)
    v_and_b32 v28, v40, v8
    v_and_b32 v29, v40, v9
    v_and_b32 v30, v40, v10
    v_and_b32 v31, v40, v11
    s_nop 1
    v_mfma_f32_16x16x32_bf16 v[24:27], v[28:31], v[100:103], v[24:27]
    s_waitcnt lgkmcnt(5)
    v_and_b32 v28, v41, v8
    v_and_b32 v29, v41, v9
    v_and_b32 v30, v41, v10
    v_and_b32 v31, v41, v11
    s_nop 1
    v_mfma_f32_16x16x32_bf16 v[24:27], v[28:31], v[104:107], v[24:27]
    s_waitcnt lgkmcnt(4)
    v_and_b32 v28, v42, v8
    v_and_b32 v29, v42, v9
    v_and_b32 v30, v42, v10
    v_and_b32 v31, v42, v11
    s_nop 1
    v_mfma_f32_16x16x32_bf16 v[24:27], v[28:31], v[108:111], v[24:27]
    s_waitcnt lgkmcnt(3)
    v_and_b32 v28, v43, v8
    v_and_b32 v29, v43, v9
    v_and_b32 v30, v43, v10
    v_and_b32 v31, v43, v11
    s_nop 1
    v_mfma_f32_16x16x32_bf16 v[24:27], v[28:31], v[112:115], v[24:27]
    s_waitcnt lgkmcnt(2)
    v_and_b32 v28, v44, v8
    v_and_b32 v29, v44, v9
    v_and_b32 v30, v44, v10
    v_and_b32 v31, v44, v11
    s_nop 1
    v_mfma_f32_16x16x32_bf16 v[24:27], v[28:31], v[116:119], v[24:27]
    s_waitcnt lgkmcnt(1)
    v_and_b32 v28, v45, v8
    v_and_b32 v29, v45, v9
    v_and_b32 v30, v45, v10
    v_and_b32 v31, v45, v11
    s_nop 1
    v_mfma_f32_16x16x32_bf16 v[24:27], v[28:31], v[120:123], v[24:27]
    s_waitcnt lgkmcnt(0)
    v_and_b32 v28, v46, v8
    v_and_b32 v29, v46, v9
    v_and_b32 v30, v46, v10
    v_and_b32 v31, v46, v11
    s_nop 1
    v_mfma_f32_16x16x32_bf16 v[24:27], v[28:31], v[124:127], v[24:27]
    ds_read_b32 v37, v36 offset:17920
    ds_read_b32 v38, v36 offset:17952
    ds_read_b32 v39, v36 offset:17984
    ds_read_b32 v40, v36 offset:18016
    ds_read_b32 v41, v36 offset:18048
    ds_read_b32 v42, v36 offset:18080
    ds_read_b32 v43, v36 offset:18112
    ds_read_b32 v44, v36 offset:18144
    ds_read_b32 v45, v36 offset:18176
    ds_read_b32 v46, v36 offset:18208
    s_waitcnt lgkmcnt(9)
    v_and_b32 v28, v37, v8
    v_and_b32 v29, v37, v9
    v_and_b32 v30, v37, v10
    v_and_b32 v31, v37, v11
    s_nop 1
    v_mfma_f32_16x16x32_bf16 v[32:35], v[28:31], v[48:51], v[32:35]
    s_waitcnt lgkmcnt(8)
    v_and_b32 v28, v38, v8
    v_and_b32 v29, v38, v9
    v_and_b32 v30, v38, v10
    v_and_b32 v31, v38, v11
    s_nop 1
    v_mfma_f32_16x16x32_bf16 v[32:35], v[28:31], v[52:55], v[32:35]
    s_waitcnt lgkmcnt(7)
    v_and_b32 v28, v39, v8
    v_and_b32 v29, v39, v9
    v_and_b32 v30, v39, v10
    v_and_b32 v31, v39, v11
    s_nop 1
    v_mfma_f32_16x16x32_bf16 v[32:35], v[28:31], v[56:59], v[32:35]
    s_waitcnt lgkmcnt(6)
    v_and_b32 v28, v40, v8
    v_and_b32 v29, v40, v9
    v_and_b32 v30, v40, v10
    v_and_b32 v31, v40, v11
    s_nop 1
    v_mfma_f32_16x16x32_bf16 v[32:35], v[28:31], v[60:63], v[32:35]
    s_waitcnt lgkmcnt(5)
    v_and_b32 v28, v41, v8
    v_and_b32 v29, v41, v9
    v_and_b32 v30, v41, v10
    v_and_b32 v31, v41, v11
    s_nop 1
    v_mfma_f32_16x16x32_bf16 v[32:35], v[28:31], v[64:67], v[32:35]
    s_waitcnt lgkmcnt(4)
    v_and_b32 v28, v42, v8
    v_and_b32 v29, v42, v9
    v_and_b32 v30, v42, v10
    v_and_b32 v31, v42, v11
    s_nop 1
    v_mfma_f32_16x16x32_bf16 v[32:35], v[28:31], v[68:71], v[32:35]
    s_waitcnt lgkmcnt(3)
    v_and_b32 v28, v43, v8
    v_and_b32 v29, v43, v9
    v_and_b32 v30, v43, v10
    v_and_b32 v31, v43, v11
    s_nop 1
    v_mfma_f32_16x16x32_bf16 v[32:35], v[28:31], v[72:75], v[32:35]
    s_waitcnt lgkmcnt(2)
    v_and_b32 v28, v44, v8
    v_and_b32 v29, v44, v9
    v_and_b32 v30, v44, v10
    v_and_b32 v31, v44, v11
    s_nop 1
    v_mfma_f32_16x16x32_bf16 v[32:35], v[28:31], v[76:79], v[32:35]
    s_waitcnt lgkmcnt(1)
    v_and_b32 v28, v45, v8
    v_and_b32 v29, v45, v9
    v_and_b32 v30, v45, v10
    v_and_b32 v31, v45, v11
    s_nop 1
    v_mfma_f32_16x16x32_bf16 v[32:35], v[28:31], v[80:83], v[32:35]
    s_waitcnt lgkmcnt(0)
    v_and_b32 v28, v46, v8
    v_and_b32 v29, v46, v9
    v_and_b32 v30, v46, v10
    v_and_b32 v31, v46, v11
    s_nop 1
    v_mfma_f32_16x16x32_bf16 v[32:35], v[28:31], v[84:87], v[32:35]
    ds_read_b32 v37, v36 offset:18240
    ds_read_b32 v38, v36 offset:18272
    ds_read_b32 v39, v36 offset:18304
    ds_read_b32 v40, v36 offset:18336
    ds_read_b32 v41, v36 offset:18368
    ds_read_b32 v42, v36 offset:18400
    ds_read_b32 v43, v36 offset:18432
    ds_read_b32 v44, v36 offset:18464
    ds_read_b32 v45, v36 offset:18496
    ds_read_b32 v46, v36 offset:18528
    s_waitcnt lgkmcnt(9)
    v_and_b32 v28, v37, v8
    v_and_b32 v29, v37, v9
    v_and_b32 v30, v37, v10
    v_and_b32 v31, v37, v11
    s_nop 1
    v_mfma_f32_16x16x32_bf16 v[32:35], v[28:31], v[88:91], v[32:35]
    s_waitcnt lgkmcnt(8)
    v_and_b32 v28, v38, v8
    v_and_b32 v29, v38, v9
    v_and_b32 v30, v38, v10
    v_and_b32 v31, v38, v11
    s_nop 1
    v_mfma_f32_16x16x32_bf16 v[32:35], v[28:31], v[92:95], v[32:35]
    s_waitcnt lgkmcnt(7)
    v_and_b32 v28, v39, v8
    v_and_b32 v29, v39, v9
    v_and_b32 v30, v39, v10
    v_and_b32 v31, v39, v11
    s_nop 1
    v_mfma_f32_16x16x32_bf16 v[32:35], v[28:31], v[96:99], v[32:35]
    s_waitcnt lgkmcnt(6)
    v_and_b32 v28, v40, v8
    v_and_b32 v29, v40, v9
    v_and_b32 v30, v40, v10
    v_and_b32 v31, v40, v11
    s_nop 1
    v_mfma_f32_16x16x32_bf16 v[32:35], v[28:31], v[100:103], v[32:35]
    s_waitcnt lgkmcnt(5)
    v_and_b32 v28, v41, v8
    v_and_b32 v29, v41, v9
    v_and_b32 v30, v41, v10
    v_and_b32 v31, v41, v11
    s_nop 1
    v_mfma_f32_16x16x32_bf16 v[32:35], v[28:31], v[104:107], v[32:35]
    s_waitcnt lgkmcnt(4)
    v_and_b32 v28, v42, v8
    v_and_b32 v29, v42, v9
    v_and_b32 v30, v42, v10
    v_and_b32 v31, v42, v11
    s_nop 1
    v_mfma_f32_16x16x32_bf16 v[32:35], v[28:31], v[108:111], v[32:35]
    s_waitcnt lgkmcnt(3)
    v_and_b32 v28, v43, v8
    v_and_b32 v29, v43, v9
    v_and_b32 v30, v43, v10
    v_and_b32 v31, v43, v11
    s_nop 1
    v_mfma_f32_16x16x32_bf16 v[32:35], v[28:31], v[112:115], v[32:35]
    s_waitcnt lgkmcnt(2)
    v_and_b32 v28, v44, v8
    v_and_b32 v29, v44, v9
    v_and_b32 v30, v44, v10
    v_and_b32 v31, v44, v11
    s_nop 1
    v_mfma_f32_16x16x32_bf16 v[32:35], v[28:31], v[116:119], v[32:35]
    s_waitcnt lgkmcnt(1)
    v_and_b32 v28, v45, v8
    v_and_b32 v29, v45, v9
    v_and_b32 v30, v45, v10
    v_and_b32 v31, v45, v11
    s_nop 1
    v_mfma_f32_16x16x32_bf16 v[32:35], v[28:31], v[120:123], v[32:35]
    s_waitcnt lgkmcnt(0)
    v_and_b32 v28, v46, v8
    v_and_b32 v29, v46, v9
    v_and_b32 v30, v46, v10
    v_and_b32 v31, v46, v11
    s_nop 1
    v_mfma_f32_16x16x32_bf16 v[32:35], v[28:31], v[124:127], v[32:35]
    s_nop 7
    v_permlane32_swap_b32 v16, v24
    v_permlane32_swap_b32 v17, v25
    v_permlane32_swap_b32 v18, v26
    v_permlane32_swap_b32 v19, v27
    v_permlane32_swap_b32 v20, v32
    v_permlane32_swap_b32 v21, v33
    v_permlane32_swap_b32 v22, v34
    v_permlane32_swap_b32 v23, v35
    s_nop 1
    v_add_f32_dpp v16, v24, v16 row_ror:8 row_mask:0xf bank_mask:0xf
    v_add_f32_dpp v17, v25, v17 row_ror:8 row_mask:0xf bank_mask:0xf
    v_add_f32_dpp v18, v26, v18 row_ror:8 row_mask:0xf bank_mask:0xf
    v_add_f32_dpp v19, v27, v19 row_ror:8 row_mask:0xf bank_mask:0xf
    v_add_f32_dpp v20, v32, v20 row_ror:8 row_mask:0xf bank_mask:0xf
    v_add_f32_dpp v21, v33, v21 row_ror:8 row_mask:0xf bank_mask:0xf
    v_add_f32_dpp v22, v34, v22 row_ror:8 row_mask:0xf bank_mask:0xf
    v_add_f32_dpp v23, v35, v23 row_ror:8 row_mask:0xf bank_mask:0xf
    s_mov_b32 exec_lo, 0x00ff00ff
    s_mov_b32 exec_hi, 0x00ff00ff
    ds_write_b128 v47, v[16:19] offset:1024
    ds_write_b128 v47, v[20:23] offset:1280
    s_mov_b64 exec, -1
    s_nop 1
    s_waitcnt vmcnt(0) lgkmcnt(0)
    v_mov_b32 v36, 0
    v_mov_b32 v37, 1
    s_mov_b64 exec, 1
    ds_add_u32 v36, v37 offset:29064
    s_mov_b64 exec, -1
    s_mov_b32 s6, 0
L_fspin:
    ds_read_b32 v38, v36 offset:29064
    s_waitcnt lgkmcnt(0)
    v_readfirstlane_b32 s8, v38
    s_add_u32 s6, s6, 1
    s_cmp_ge_u32 s8, 4
    s_cbranch_scc1 L_fspin_done
    s_sleep 2
    s_cmp_lt_u32 s6, 0x100000
    s_cbranch_scc1 L_fspin
L_fspin_done:
    s_lshl_b32 s8, s14, 9
    v_lshlrev_b32 v36, 2, v1
    v_add_u32 v36, s8, v36
    v_add_u32 v42, 114688, v36
    v_lshlrev_b32 v38, 16, v13
    ds_read_b32 v28, v42 offset:0
    ds_read_b32 v29, v42 offset:2048
    ds_read_b32 v30, v42 offset:4096
    ds_read_b32 v31, v42 offset:6144
    s_waitcnt lgkmcnt(0)
    v_add_f32 v39, v28, v29
    v_add_f32 v39, v39, v30
    v_add_f32 v39, v39, v31
    v_cvt_pk_bf16_f32 v39, v39, v39
    v_and_b32 v39, 0xffff0000, v39
    v_add_f32 v39, v39, v38
    v_cvt_pk_bf16_f32 v39, v39, v39
    v_and_b32 v39, 0xffff0000, v39
    v_mul_f32 v40, v39, v39
    v_mul_f32 v40, v40, v39
    v_mov_b32 v41, 0x3d372713
    v_fma_f32 v40, v40, v41, v39
    v_mul_f32 v40, 0xc0135761, v40
    v_exp_f32 v40, v40
    s_nop 0
    v_add_f32 v40, 1.0, v40
    v_rcp_f32 v40, v40
    s_nop 0
    v_mul_f32 v39, v39, v40
    v_cvt_pk_bf16_f32 v39, v39, v39
    ds_write_b32 v36, v39 offset:30720
    ds_read_b32 v28, v42 offset:256
    ds_read_b32 v29, v42 offset:2304
    ds_read_b32 v30, v42 offset:4352
    ds_read_b32 v31, v42 offset:6400
    s_waitcnt lgkmcnt(0)
    v_add_f32 v39, v28, v29
    v_add_f32 v39, v39, v30
    v_add_f32 v39, v39, v31
    v_cvt_pk_bf16_f32 v39, v39, v39
    v_and_b32 v39, 0xffff0000, v39
    v_add_f32 v39, v39, v38
    v_cvt_pk_bf16_f32 v39, v39, v39
    v_and_b32 v39, 0xffff0000, v39
    v_mul_f32 v40, v39, v39
    v_mul_f32 v40, v40, v39
    v_mov_b32 v41, 0x3d372713
    v_fma_f32 v40, v40, v41, v39
    v_mul_f32 v40, 0xc0135761, v40
    v_exp_f32 v40, v40
    s_nop 0
    v_add_f32 v40, 1.0, v40
    v_rcp_f32 v40, v40
    s_nop 0
    v_mul_f32 v39, v39, v40
    v_cvt_pk_bf16_f32 v39, v39, v39
    ds_write_b32 v36, v39 offset:30976
    s_waitcnt lgkmcnt(0)
    s_lshl_b32 s8, s14, 7
    v_lshrrev_b32 v36, 3, v3
    v_lshlrev_b32 v36, 6, v36
    v_add_u32 v36, s8, v36
    v_add_u32 v36, v36, v2
    v_lshlrev_b32 v36, 2, v36
    ds_read_b32 v108, v36 offset:30720
    ds_read_b32 v109, v36 offset:30736
    ds_read_b32 v110, v36 offset:30752
    ds_read_b32 v111, v36 offset:30768
    ds_read_b32 v112, v36 offset:30784
    ds_read_b32 v113, v36 offset:30800
    ds_read_b32 v114, v36 offset:30816
    ds_read_b32 v115, v36 offset:30832
    ds_read_b32 v116, v36 offset:30848
    ds_read_b32 v117, v36 offset:30864
    ds_read_b32 v118, v36 offset:30880
    ds_read_b32 v119, v36 offset:30896
    ds_read_b32 v120, v36 offset:30912
    ds_read_b32 v121, v36 offset:30928
    ds_read_b32 v122, v36 offset:30944
    ds_read_b32 v123, v36 offset:30960
    s_movk_i32 s9, 1280
    v_mul_lo_u32 v37, v2, s9
    v_lshl_add_u32 v37, v3, 4, v37
    v_add_u32 v37, 32768, v37
    v_add_u32 v38, 40960, v37
    v_mov_b32 v48, 0
    v_mov_b32 v49, 0
    v_mov_b32 v50, 0
    v_mov_b32 v51, 0
    v_mov_b32 v52, 0
    v_mov_b32 v53, 0
    v_mov_b32 v54, 0
    v_mov_b32 v55, 0
    v_mov_b32 v56, 0
    v_mov_b32 v57, 0
    v_mov_b32 v58, 0
    v_mov_b32 v59, 0
    v_mov_b32 v60, 0
    v_mov_b32 v61, 0
    v_mov_b32 v62, 0
    v_mov_b32 v63, 0
    v_mov_b32 v64, 0
    v_mov_b32 v65, 0
    v_mov_b32 v66, 0
    v_mov_b32 v67, 0
    ds_read_b128 v[68:71], v37 offset:0
    ds_read_b128 v[72:75], v37 offset:256
    ds_read_b128 v[76:79], v37 offset:512
    ds_read_b128 v[80:83], v37 offset:768
    ds_read_b128 v[84:87], v37 offset:1024
    ds_read_b128 v[88:91], v37 offset:5120
    ds_read_b128 v[92:95], v37 offset:5376
    ds_read_b128 v[96:99], v37 offset:5632
    ds_read_b128 v[100:103], v37 offset:5888
    ds_read_b128 v[104:107], v37 offset:6144
    s_waitcnt lgkmcnt(5)
    v_and_b32 v28, v108, v8
    v_and_b32 v29, v108, v9
    v_and_b32 v30, v108, v10
    v_and_b32 v31, v108, v11
    s_nop 1
    v_mfma_f32_16x16x32_bf16 v[48:51], v[28:31], v[68:71], v[48:51]
    v_mfma_f32_16x16x32_bf16 v[52:55], v[28:31], v[72:75], v[52:55]
    v_mfma_f32_16x16x32_bf16 v[56:59], v[28:31], v[76:79], v[56:59]
    v_mfma_f32_16x16x32_bf16 v[60:63], v[28:31], v[80:83], v[60:63]
    v_mfma_f32_16x16x32_bf16 v[64:67], v[28:31], v[84:87], v[64:67]
    s_nop 7
    ds_read_b128 v[68:71], v37 offset:10240
    ds_read_b128 v[72:75], v37 offset:10496
    ds_read_b128 v[76:79], v37 offset:10752
    ds_read_b128 v[80:83], v37 offset:11008
    ds_read_b128 v[84:87], v37 offset:11264
    s_waitcnt lgkmcnt(5)
    v_and_b32 v28, v109, v8
    v_and_b32 v29, v109, v9
    v_and_b32 v30, v109, v10
    v_and_b32 v31, v109, v11
    s_nop 1
    v_mfma_f32_16x16x32_bf16 v[48:51], v[28:31], v[88:91], v[48:51]
    v_mfma_f32_16x16x32_bf16 v[52:55], v[28:31], v[92:95], v[52:55]
    v_mfma_f32_16x16x32_bf16 v[56:59], v[28:31], v[96:99], v[56:59]
    v_mfma_f32_16x16x32_bf16 v[60:63], v[28:31], v[100:103], v[60:63]
    v_mfma_f32_16x16x32_bf16 v[64:67], v[28:31], v[104:107], v[64:67]
    s_nop 7
    ds_read_b128 v[88:91], v37 offset:15360
    ds_read_b128 v[92:95], v37 offset:15616
    ds_read_b128 v[96:99], v37 offset:15872
    ds_read_b128 v[100:103], v37 offset:16128
    ds_read_b128 v[104:107], v37 offset:16384
    s_waitcnt lgkmcnt(5)
    v_and_b32 v28, v110, v8
    v_and_b32 v29, v110, v9
    v_and_b32 v30, v110, v10
    v_and_b32 v31, v110, v11
    s_nop 1
    v_mfma_f32_16x16x32_bf16 v[48:51], v[28:31], v[68:71], v[48:51]
    v_mfma_f32_16x16x32_bf16 v[52:55], v[28:31], v[72:75], v[52:55]
    v_mfma_f32_16x16x32_bf16 v[56:59], v[28:31], v[76:79], v[56:59]
    v_mfma_f32_16x16x32_bf16 v[60:63], v[28:31], v[80:83], v[60:63]
    v_mfma_f32_16x16x32_bf16 v[64:67], v[28:31], v[84:87], v[64:67]
    s_nop 7
    ds_read_b128 v[68:71], v37 offset:20480
    ds_read_b128 v[72:75], v37 offset:20736
    ds_read_b128 v[76:79], v37 offset:20992
    ds_read_b128 v[80:83], v37 offset:21248
    ds_read_b128 v[84:87], v37 offset:21504
    s_waitcnt lgkmcnt(5)
    v_and_b32 v28, v111, v8
    v_and_b32 v29, v111, v9
    v_and_b32 v30, v111, v10
    v_and_b32 v31, v111, v11
    s_nop 1
    v_mfma_f32_16x16x32_bf16 v[48:51], v[28:31], v[88:91], v[48:51]
    v_mfma_f32_16x16x32_bf16 v[52:55], v[28:31], v[92:95], v[52:55]
    v_mfma_f32_16x16x32_bf16 v[56:59], v[28:31], v[96:99], v[56:59]
    v_mfma_f32_16x16x32_bf16 v[60:63], v[28:31], v[100:103], v[60:63]
    v_mfma_f32_16x16x32_bf16 v[64:67], v[28:31], v[104:107], v[64:67]
    s_nop 7
    ds_read_b128 v[88:91], v37 offset:25600
    ds_read_b128 v[92:95], v37 offset:25856
    ds_read_b128 v[96:99], v37 offset:26112
    ds_read_b128 v[100:103], v37 offset:26368
    ds_read_b128 v[104:107], v37 offset:26624
    s_waitcnt lgkmcnt(5)
    v_and_b32 v28, v112, v8
    v_and_b32 v29, v112, v9
    v_and_b32 v30, v112, v10
    v_and_b32 v31, v112, v11
    s_nop 1
    v_mfma_f32_16x16x32_bf16 v[48:51], v[28:31], v[68:71], v[48:51]
    v_mfma_f32_16x16x32_bf16 v[52:55], v[28:31], v[72:75], v[52:55]
    v_mfma_f32_16x16x32_bf16 v[56:59], v[28:31], v[76:79], v[56:59]
    v_mfma_f32_16x16x32_bf16 v[60:63], v[28:31], v[80:83], v[60:63]
    v_mfma_f32_16x16x32_bf16 v[64:67], v[28:31], v[84:87], v[64:67]
    s_nop 7
    ds_read_b128 v[68:71], v37 offset:30720
    ds_read_b128 v[72:75], v37 offset:30976
    ds_read_b128 v[76:79], v37 offset:31232
    ds_read_b128 v[80:83], v37 offset:31488
    ds_read_b128 v[84:87], v37 offset:31744
    s_waitcnt lgkmcnt(5)
    v_and_b32 v28, v113, v8
    v_and_b32 v29, v113, v9
    v_and_b32 v30, v113, v10
    v_and_b32 v31, v113, v11
    s_nop 1
    v_mfma_f32_16x16x32_bf16 v[48:51], v[28:31], v[88:91], v[48:51]
    v_mfma_f32_16x16x32_bf16 v[52:55], v[28:31], v[92:95], v[52:55]
    v_mfma_f32_16x16x32_bf16 v[56:59], v[28:31], v[96:99], v[56:59]
    v_mfma_f32_16x16x32_bf16 v[60:63], v[28:31], v[100:103], v[60:63]
    v_mfma_f32_16x16x32_bf16 v[64:67], v[28:31], v[104:107], v[64:67]
    s_nop 7
    ds_read_b128 v[88:91], v37 offset:35840
    ds_read_b128 v[92:95], v37 offset:36096
    ds_read_b128 v[96:99], v37 offset:36352
    ds_read_b128 v[100:103], v37 offset:36608
    ds_read_b128 v[104:107], v37 offset:36864
    s_waitcnt lgkmcnt(5)
    v_and_b32 v28, v114, v8
    v_and_b32 v29, v114, v9
    v_and_b32 v30, v114, v10
    v_and_b32 v31, v114, v11
    s_nop 1
    v_mfma_f32_16x16x32_bf16 v[48:51], v[28:31], v[68:71], v[48:51]
    v_mfma_f32_16x16x32_bf16 v[52:55], v[28:31], v[72:75], v[52:55]
    v_mfma_f32_16x16x32_bf16 v[56:59], v[28:31], v[76:79], v[56:59]
    v_mfma_f32_16x16x32_bf16 v[60:63], v[28:31], v[80:83], v[60:63]
    v_mfma_f32_16x16x32_bf16 v[64:67], v[28:31], v[84:87], v[64:67]
    s_nop 7
    ds_read_b128 v[68:71], v38 offset:0
    ds_read_b128 v[72:75], v38 offset:256
    ds_read_b128 v[76:79], v38 offset:512
    ds_read_b128 v[80:83], v38 offset:768
    ds_read_b128 v[84:87], v38 offset:1024
    s_waitcnt lgkmcnt(5)
    v_and_b32 v28, v115, v8
    v_and_b32 v29, v115, v9
    v_and_b32 v30, v115, v10
    v_and_b32 v31, v115, v11
    s_nop 1
    v_mfma_f32_16x16x32_bf16 v[48:51], v[28:31], v[88:91], v[48:51]
    v_mfma_f32_16x16x32_bf16 v[52:55], v[28:31], v[92:95], v[52:55]
    v_mfma_f32_16x16x32_bf16 v[56:59], v[28:31], v[96:99], v[56:59]
    v_mfma_f32_16x16x32_bf16 v[60:63], v[28:31], v[100:103], v[60:63]
    v_mfma_f32_16x16x32_bf16 v[64:67], v[28:31], v[104:107], v[64:67]
    s_nop 7
    ds_read_b128 v[88:91], v38 offset:5120
    ds_read_b128 v[92:95], v38 offset:5376
    ds_read_b128 v[96:99], v38 offset:5632
    ds_read_b128 v[100:103], v38 offset:5888
    ds_read_b128 v[104:107], v38 offset:6144
    s_waitcnt lgkmcnt(5)
    v_and_b32 v28, v116, v8
    v_and_b32 v29, v116, v9
    v_and_b32 v30, v116, v10
    v_and_b32 v31, v116, v11
    s_nop 1
    v_mfma_f32_16x16x32_bf16 v[48:51], v[28:31], v[68:71], v[48:51]
    v_mfma_f32_16x16x32_bf16 v[52:55], v[28:31], v[72:75], v[52:55]
    v_mfma_f32_16x16x32_bf16 v[56:59], v[28:31], v[76:79], v[56:59]
    v_mfma_f32_16x16x32_bf16 v[60:63], v[28:31], v[80:83], v[60:63]
    v_mfma_f32_16x16x32_bf16 v[64:67], v[28:31], v[84:87], v[64:67]
    s_nop 7
    ds_read_b128 v[68:71], v38 offset:10240
    ds_read_b128 v[72:75], v38 offset:10496
    ds_read_b128 v[76:79], v38 offset:10752
    ds_read_b128 v[80:83], v38 offset:11008
    ds_read_b128 v[84:87], v38 offset:11264
    s_waitcnt lgkmcnt(5)
    v_and_b32 v28, v117, v8
    v_and_b32 v29, v117, v9
    v_and_b32 v30, v117, v10
    v_and_b32 v31, v117, v11
    s_nop 1
    v_mfma_f32_16x16x32_bf16 v[48:51], v[28:31], v[88:91], v[48:51]
    v_mfma_f32_16x16x32_bf16 v[52:55], v[28:31], v[92:95], v[52:55]
    v_mfma_f32_16x16x32_bf16 v[56:59], v[28:31], v[96:99], v[56:59]
    v_mfma_f32_16x16x32_bf16 v[60:63], v[28:31], v[100:103], v[60:63]
    v_mfma_f32_16x16x32_bf16 v[64:67], v[28:31], v[104:107], v[64:67]
    s_nop 7
    ds_read_b128 v[88:91], v38 offset:15360
    ds_read_b128 v[92:95], v38 offset:15616
    ds_read_b128 v[96:99], v38 offset:15872
    ds_read_b128 v[100:103], v38 offset:16128
    ds_read_b128 v[104:107], v38 offset:16384
    s_waitcnt lgkmcnt(5)
    v_and_b32 v28, v118, v8
    v_and_b32 v29, v118, v9
    v_and_b32 v30, v118, v10
    v_and_b32 v31, v118, v11
    s_nop 1
    v_mfma_f32_16x16x32_bf16 v[48:51], v[28:31], v[68:71], v[48:51]
    v_mfma_f32_16x16x32_bf16 v[52:55], v[28:31], v[72:75], v[52:55]
    v_mfma_f32_16x16x32_bf16 v[56:59], v[28:31], v[76:79], v[56:59]
    v_mfma_f32_16x16x32_bf16 v[60:63], v[28:31], v[80:83], v[60:63]
    v_mfma_f32_16x16x32_bf16 v[64:67], v[28:31], v[84:87], v[64:67]
    s_nop 7
    ds_read_b128 v[68:71], v38 offset:20480
    ds_read_b128 v[72:75], v38 offset:20736
    ds_read_b128 v[76:79], v38 offset:20992
    ds_read_b128 v[80:83], v38 offset:21248
    ds_read_b128 v[84:87], v38 offset:21504
    s_waitcnt lgkmcnt(5)
    v_and_b32 v28, v119, v8
    v_and_b32 v29, v119, v9
    v_and_b32 v30, v119, v10
    v_and_b32 v31, v119, v11
    s_nop 1
    v_mfma_f32_16x16x32_bf16 v[48:51], v[28:31], v[88:91], v[48:51]
    v_mfma_f32_16x16x32_bf16 v[52:55], v[28:31], v[92:95], v[52:55]
    v_mfma_f32_16x16x32_bf16 v[56:59], v[28:31], v[96:99], v[56:59]
    v_mfma_f32_16x16x32_bf16 v[60:63], v[28:31], v[100:103], v[60:63]
    v_mfma_f32_16x16x32_bf16 v[64:67], v[28:31], v[104:107], v[64:67]
    s_nop 7
    ds_read_b128 v[88:91], v38 offset:25600
    ds_read_b128 v[92:95], v38 offset:25856
    ds_read_b128 v[96:99], v38 offset:26112
    ds_read_b128 v[100:103], v38 offset:26368
    ds_read_b128 v[104:107], v38 offset:26624
    s_waitcnt lgkmcnt(5)
    v_and_b32 v28, v120, v8
    v_and_b32 v29, v120, v9
    v_and_b32 v30, v120, v10
    v_and_b32 v31, v120, v11
    s_nop 1
    v_mfma_f32_16x16x32_bf16 v[48:51], v[28:31], v[68:71], v[48:51]
    v_mfma_f32_16x16x32_bf16 v[52:55], v[28:31], v[72:75], v[52:55]
    v_mfma_f32_16x16x32_bf16 v[56:59], v[28:31], v[76:79], v[56:59]
    v_mfma_f32_16x16x32_bf16 v[60:63], v[28:31], v[80:83], v[60:63]
    v_mfma_f32_16x16x32_bf16 v[64:67], v[28:31], v[84:87], v[64:67]
    s_nop 7
    ds_read_b128 v[68:71], v38 offset:30720
    ds_read_b128 v[72:75], v38 offset:30976
    ds_read_b128 v[76:79], v38 offset:31232
    ds_read_b128 v[80:83], v38 offset:31488
    ds_read_b128 v[84:87], v38 offset:31744
    s_waitcnt lgkmcnt(5)
    v_and_b32 v28, v121, v8
    v_and_b32 v29, v121, v9
    v_and_b32 v30, v121, v10
    v_and_b32 v31, v121, v11
    s_nop 1
    v_mfma_f32_16x16x32_bf16 v[48:51], v[28:31], v[88:91], v[48:51]
    v_mfma_f32_16x16x32_bf16 v[52:55], v[28:31], v[92:95], v[52:55]
    v_mfma_f32_16x16x32_bf16 v[56:59], v[28:31], v[96:99], v[56:59]
    v_mfma_f32_16x16x32_bf16 v[60:63], v[28:31], v[100:103], v[60:63]
    v_mfma_f32_16x16x32_bf16 v[64:67], v[28:31], v[104:107], v[64:67]
    s_nop 7
    ds_read_b128 v[88:91], v38 offset:35840
    ds_read_b128 v[92:95], v38 offset:36096
    ds_read_b128 v[96:99], v38 offset:36352
    ds_read_b128 v[100:103], v38 offset:36608
    ds_read_b128 v[104:107], v38 offset:36864
    s_waitcnt lgkmcnt(5)
    v_and_b32 v28, v122, v8
    v_and_b32 v29, v122, v9
    v_and_b32 v30, v122, v10
    v_and_b32 v31, v122, v11
    s_nop 1
    v_mfma_f32_16x16x32_bf16 v[48:51], v[28:31], v[68:71], v[48:51]
    v_mfma_f32_16x16x32_bf16 v[52:55], v[28:31], v[72:75], v[52:55]
    v_mfma_f32_16x16x32_bf16 v[56:59], v[28:31], v[76:79], v[56:59]
    v_mfma_f32_16x16x32_bf16 v[60:63], v[28:31], v[80:83], v[60:63]
    v_mfma_f32_16x16x32_bf16 v[64:67], v[28:31], v[84:87], v[64:67]
    s_nop 7
    s_waitcnt lgkmcnt(0)
    v_and_b32 v28, v123, v8
    v_and_b32 v29, v123, v9
    v_and_b32 v30, v123, v10
    v_and_b32 v31, v123, v11
    s_nop 1
    v_mfma_f32_16x16x32_bf16 v[48:51], v[28:31], v[88:91], v[48:51]
    v_mfma_f32_16x16x32_bf16 v[52:55], v[28:31], v[92:95], v[52:55]
    v_mfma_f32_16x16x32_bf16 v[56:59], v[28:31], v[96:99], v[56:59]
    v_mfma_f32_16x16x32_bf16 v[60:63], v[28:31], v[100:103], v[60:63]
    v_mfma_f32_16x16x32_bf16 v[64:67], v[28:31], v[104:107], v[64:67]
    s_nop 7
    v_lshrrev_b32 v36, 1, v2
    s_lshl_b32 s8, s14, 1
    v_add_u32 v36, s8, v36
    s_mov_b32 s9, 151040
    v_mul_lo_u32 v36, v36, s9
    s_add_u32 s8, s7, 32
    s_mul_i32 s8, s8, 2560
    v_add_u32 v36, s8, v36
    v_lshl_add_u32 v36, v3, 5, v36
    v_and_b32 v37, 1, v2
    v_lshl_add_u32 v36, v37, 4, v36
    global_store_dwordx4 v36, v[48:51], s[40:41] offset:0 sc1
    global_store_dwordx4 v36, v[52:55], s[40:41] offset:512 sc1
    global_store_dwordx4 v36, v[56:59], s[40:41] offset:1024 sc1
    global_store_dwordx4 v36, v[60:63], s[40:41] offset:1536 sc1
    global_store_dwordx4 v36, v[64:67], s[40:41] offset:2048 sc1
    s_waitcnt vmcnt(0)
    s_mov_b64 exec, 3
    s_lshl_b32 s8, s14, 1
    v_add_u32 v36, s8, v1
    v_lshlrev_b32 v39, 2, v36
    v_mov_b32 v37, 1
    global_atomic_add v38, v39, v37, s[38:39] sc0
    s_waitcnt vmcnt(0)
    v_lshlrev_b32 v37, v36, v37
    v_cmp_eq_u32 vcc, 58, v38
    s_nop 1
    v_cndmask_b32 v37, 0, v37, vcc
    v_mov_b32 v36, 0
    ds_or_b32 v36, v37 offset:29056
    s_mov_b64 exec, -1
    s_setprio 0
    s_mov_b32 s13, 16
    v_lshlrev_b32 v36, 4, v3
    ds_read_b128 v[16:19], v36 offset:28672
    s_branch L_kinit
L_mid0:
    s_mov_b32 s12, 0
    s_branch L_mid
L_mid1:
    s_mov_b32 s12, 1
L_mid:
    s_nop 1
    v_max_f32_dpp v46, v46, v46 row_ror:8 row_mask:0xf bank_mask:0xf
    s_nop 1
    v_max_f32_dpp v46, v46, v46 row_ror:4 row_mask:0xf bank_mask:0xf
    s_nop 1
    v_max_f32_dpp v46, v46, v46 row_ror:2 row_mask:0xf bank_mask:0xf
    s_nop 1
    v_max_f32_dpp v46, v46, v46 row_ror:1 row_mask:0xf bank_mask:0xf
    s_nop 1
    v_readlane_b32 s8, v46, 0
    v_readlane_b32 s9, v46, 16
    v_readlane_b32 s10, v46, 32
    v_readlane_b32 s11, v46, 48
    s_nop 1
    v_mov_b32 v46, s8
    v_max_f32 v46, s9, v46
    v_max_f32 v46, s10, v46
    v_max_f32 v46, s11, v46
    s_lshl_b32 s8, s3, 2
    v_mov_b32 v36, s8
    s_mov_b64 exec, 1
    ds_write_b32 v36, v46 offset:28928
    s_mov_b64 exec, -1
    s_waitcnt lgkmcnt(0)
    s_barrier
    ds_read_b128 v[28:31], v23 offset:28928
    ds_read_b128 v[32:35], v23 offset:28944
    s_waitcnt lgkmcnt(0)
    v_max3_f32 v46, v46, v28, v29
    v_max3_f32 v46, v46, v30, v31
    v_max3_f32 v46, v46, v32, v33
    v_max3_f32 v46, v46, v34, v35
    ds_read_b128 v[28:31], v23 offset:28960
    ds_read_b128 v[32:35], v23 offset:28976
    s_waitcnt lgkmcnt(0)
    v_max3_f32 v46, v46, v28, v29
    v_max3_f32 v46, v46, v30, v31
    v_max3_f32 v46, v46, v32, v33
    v_max3_f32 v46, v46, v34, v35
    s_lshl_b32 s8, s3, 3
    v_add_u32 v45, s8, v2
    s_movk_i32 s9, 1280
    v_mul_lo_u32 v45, v45, s9
    v_lshl_add_u32 v45, v3, 4, v45
    s_mov_b32 s6, 0
    buffer_load_dwordx4 v[80:83], v45, s[60:63], s6 offen
    s_mov_b32 s6, 256
    buffer_load_dwordx4 v[84:87], v45, s[60:63], s6 offen
    s_mov_b32 s6, 512
    buffer_load_dwordx4 v[88:91], v45, s[60:63], s6 offen
    s_mov_b32 s6, 768
    buffer_load_dwordx4 v[92:95], v45, s[60:63], s6 offen
    s_mov_b32 s6, 1024
    buffer_load_dwordx4 v[96:99], v45, s[60:63], s6 offen
    s_mov_b32 s6, 5120
    buffer_load_dwordx4 v[100:103], v45, s[60:63], s6 offen
    s_mov_b32 s6, 5376
    buffer_load_dwordx4 v[104:107], v45, s[60:63], s6 offen
    s_mov_b32 s6, 5632
    buffer_load_dwordx4 v[108:111], v45, s[60:63], s6 offen
    s_mov_b32 s6, 5888
    buffer_load_dwordx4 v[112:115], v45, s[60:63], s6 offen
    s_mov_b32 s6, 6144
    buffer_load_dwordx4 v[116:119], v45, s[60:63], s6 offen
    s_cmp_eq_u32 s12, 1
    s_cbranch_scc1 L_v1
L_v0:
    s_cmp_ge_u32 s42, 512
    s_cbranch_scc1 L_vdone
    s_sub_u32 s8, s42, 256
    s_lshl_b32 s8, s8, 6
    v_add_u32 v36, s8, v20
    ds_read_b32 v22, v36
    s_waitcnt lgkmcnt(0)
    v_readfirstlane_b32 s42, v14
    v_sub_f32 v22, v22, v46
    v_exp_f32 v22, v22
    s_nop 0
    v_add_f32 v47, v47, v22
    v_cvt_pk_bf16_f32 v22, v22, v22
    s_cmp_lt_u32 s43, 512
    s_cbranch_scc1 L_vw0
    s_waitcnt vmcnt(0)
L_vw0:
    s_waitcnt vmcnt(4)
    s_nop 0
    v_and_b32_dpp v28, v22, v4 row_newbcast:0 row_mask:0xf bank_mask:0xf
    v_and_b32_dpp v29, v22, v5 row_newbcast:0 row_mask:0xf bank_mask:0xf
    v_and_b32_dpp v30, v22, v6 row_newbcast:0 row_mask:0xf bank_mask:0xf
    v_and_b32_dpp v31, v22, v7 row_newbcast:0 row_mask:0xf bank_mask:0xf
    v_and_b32_dpp v32, v22, v4 row_newbcast:1 row_mask:0xf bank_mask:0xf
    v_and_b32_dpp v33, v22, v5 row_newbcast:1 row_mask:0xf bank_mask:0xf
    v_and_b32_dpp v34, v22, v6 row_newbcast:1 row_mask:0xf bank_mask:0xf
    v_and_b32_dpp v35, v22, v7 row_newbcast:1 row_mask:0xf bank_mask:0xf
    s_nop 0
    v_mfma_f32_16x16x32_bf16 v[24:27], v[28:31], v[48:51], v[24:27]
    v_mfma_f32_16x16x32_bf16 v[24:27], v[32:35], v[52:55], v[24:27]
    v_and_b32_dpp v28, v22, v4 row_newbcast:2 row_mask:0xf bank_mask:0xf
    v_and_b32_dpp v29, v22, v5 row_newbcast:2 row_mask:0xf bank_mask:0xf
    v_and_b32_dpp v30, v22, v6 row_newbcast:2 row_mask:0xf bank_mask:0xf
    v_and_b32_dpp v31, v22, v7 row_newbcast:2 row_mask:0xf bank_mask:0xf
    v_and_b32_dpp v32, v22, v4 row_newbcast:3 row_mask:0xf bank_mask:0xf
    v_and_b32_dpp v33, v22, v5 row_newbcast:3 row_mask:0xf bank_mask:0xf
    v_and_b32_dpp v34, v22, v6 row_newbcast:3 row_mask:0xf bank_mask:0xf
    v_and_b32_dpp v35, v22, v7 row_newbcast:3 row_mask:0xf bank_mask:0xf
    s_nop 0
    v_mfma_f32_16x16x32_bf16 v[24:27], v[28:31], v[56:59], v[24:27]
    v_mfma_f32_16x16x32_bf16 v[24:27], v[32:35], v[60:63], v[24:27]
    s_cmp_ge_u32 s42, 512
    s_cbranch_scc1 L_ig7
    s_cmp_lt_u32 s42, 256
    s_cselect_b64 s[76:77], s[44:45], s[48:49]
    s_add_u32 s6, s42, s100
    s_and_b32 s6, s6, 255
    s_lshl_b32 s6, s6, 12
    buffer_load_dwordx4 v[48:51], v12, s[76:79], s6 offen offset:0 nt
    buffer_load_dwordx4 v[52:55], v12, s[76:79], s6 offen offset:1024 nt
    buffer_load_dwordx4 v[56:59], v12, s[76:79], s6 offen offset:2048 nt
    buffer_load_dwordx4 v[60:63], v12, s[76:79], s6 offen offset:3072 nt
L_ig7:
    s_mov_b64 exec, 1
    ds_add_rtn_u32 v14, v23, v21 offset:29060
    s_mov_b64 exec, -1
L_v1:
    s_cmp_ge_u32 s43, 512
    s_cbranch_scc1 L_vdone
    s_sub_u32 s8, s43, 256
    s_lshl_b32 s8, s8, 6
    v_add_u32 v36, s8, v20
    ds_read_b32 v22, v36
    s_waitcnt lgkmcnt(0)
    v_readfirstlane_b32 s43, v14
    v_sub_f32 v22, v22, v46
    v_exp_f32 v22, v22
    s_nop 0
    v_add_f32 v47, v47, v22
    v_cvt_pk_bf16_f32 v22, v22, v22
    s_cmp_lt_u32 s42, 512
    s_cbranch_scc1 L_vw1
    s_waitcnt vmcnt(0)
L_vw1:
    s_waitcnt vmcnt(4)
    s_nop 0
    v_and_b32_dpp v28, v22, v4 row_newbcast:0 row_mask:0xf bank_mask:0xf
    v_and_b32_dpp v29, v22, v5 row_newbcast:0 row_mask:0xf bank_mask:0xf
    v_and_b32_dpp v30, v22, v6 row_newbcast:0 row_mask:0xf bank_mask:0xf
    v_and_b32_dpp v31, v22, v7 row_newbcast:0 row_mask:0xf bank_mask:0xf
    v_and_b32_dpp v32, v22, v4 row_newbcast:1 row_mask:0xf bank_mask:0xf
    v_and_b32_dpp v33, v22, v5 row_newbcast:1 row_mask:0xf bank_mask:0xf
    v_and_b32_dpp v34, v22, v6 row_newbcast:1 row_mask:0xf bank_mask:0xf
    v_and_b32_dpp v35, v22, v7 row_newbcast:1 row_mask:0xf bank_mask:0xf
    s_nop 0
    v_mfma_f32_16x16x32_bf16 v[24:27], v[28:31], v[64:67], v[24:27]
    v_mfma_f32_16x16x32_bf16 v[24:27], v[32:35], v[68:71], v[24:27]
    v_and_b32_dpp v28, v22, v4 row_newbcast:2 row_mask:0xf bank_mask:0xf
    v_and_b32_dpp v29, v22, v5 row_newbcast:2 row_mask:0xf bank_mask:0xf
    v_and_b32_dpp v30, v22, v6 row_newbcast:2 row_mask:0xf bank_mask:0xf
    v_and_b32_dpp v31, v22, v7 row_newbcast:2 row_mask:0xf bank_mask:0xf
    v_and_b32_dpp v32, v22, v4 row_newbcast:3 row_mask:0xf bank_mask:0xf
    v_and_b32_dpp v33, v22, v5 row_newbcast:3 row_mask:0xf bank_mask:0xf
    v_and_b32_dpp v34, v22, v6 row_newbcast:3 row_mask:0xf bank_mask:0xf
    v_and_b32_dpp v35, v22, v7 row_newbcast:3 row_mask:0xf bank_mask:0xf
    s_nop 0
    v_mfma_f32_16x16x32_bf16 v[24:27], v[28:31], v[72:75], v[24:27]
    v_mfma_f32_16x16x32_bf16 v[24:27], v[32:35], v[76:79], v[24:27]
    s_cmp_ge_u32 s43, 512
    s_cbranch_scc1 L_ig8
    s_cmp_lt_u32 s43, 256
    s_cselect_b64 s[76:77], s[44:45], s[48:49]
    s_add_u32 s6, s43, s100
    s_and_b32 s6, s6, 255
    s_lshl_b32 s6, s6, 12
    buffer_load_dwordx4 v[64:67], v12, s[76:79], s6 offen offset:0 nt
    buffer_load_dwordx4 v[68:71], v12, s[76:79], s6 offen offset:1024 nt
    buffer_load_dwordx4 v[72:75], v12, s[76:79], s6 offen offset:2048 nt
    buffer_load_dwordx4 v[76:79], v12, s[76:79], s6 offen offset:3072 nt
L_ig8:
    s_mov_b64 exec, 1
    ds_add_rtn_u32 v14, v23, v21 offset:29060
    s_mov_b64 exec, -1
    s_branch L_v0
L_vdone:
    s_nop 1
    v_add_f32_dpp v47, v47, v47 row_ror:8 row_mask:0xf bank_mask:0xf
    s_nop 1
    v_add_f32_dpp v47, v47, v47 row_ror:4 row_mask:0xf bank_mask:0xf
    s_nop 1
    v_add_f32_dpp v47, v47, v47 row_ror:2 row_mask:0xf bank_mask:0xf
    s_nop 1
    v_add_f32_dpp v47, v47, v47 row_ror:1 row_mask:0xf bank_mask:0xf
    s_nop 1
    v_readlane_b32 s8, v47, 0
    v_readlane_b32 s9, v47, 16
    v_readlane_b32 s10, v47, 32
    v_readlane_b32 s11, v47, 48
    s_nop 1
    v_mov_b32 v47, s8
    v_add_f32 v47, s9, v47
    v_add_f32 v47, s10, v47
    v_add_f32 v47, s11, v47
    v_mul_f32 v47, 0x3e800000, v47
    v_lshlrev_b32 v38, 5, v3
    v_lshl_add_u32 v38, v2, 4, v38
    s_lshl_b32 s8, s3, 9
    v_add_u32 v38, s8, v38
    s_lshl_b32 s8, s3, 2
    v_mov_b32 v39, s8
    s_nop 7
    s_mov_b32 exec_hi, 0
    ds_write_b128 v38, v[24:27] offset:20480
    s_mov_b64 exec, 1
    ds_write_b32 v39, v47 offset:28992
    s_mov_b64 exec, -1
    s_waitcnt lgkmcnt(0)
    s_barrier
    s_cmp_ge_u32 s3, 2
    s_cbranch_scc1 L_c_skip
    ds_read_b128 v[48:51], v23 offset:28992
    ds_read_b128 v[52:55], v23 offset:29008
    ds_read_b128 v[56:59], v23 offset:29024
    ds_read_b128 v[60:63], v23 offset:29040
    v_lshlrev_b32 v36, 2, v0
    ds_read_b32 v64, v36 offset:20480
    ds_read_b32 v65, v36 offset:20992
    ds_read_b32 v66, v36 offset:21504
    ds_read_b32 v67, v36 offset:22016
    ds_read_b32 v68, v36 offset:22528
    ds_read_b32 v69, v36 offset:23040
    ds_read_b32 v70, v36 offset:23552
    ds_read_b32 v71, v36 offset:24064
    ds_read_b32 v72, v36 offset:24576
    ds_read_b32 v73, v36 offset:25088
    ds_read_b32 v74, v36 offset:25600
    ds_read_b32 v75, v36 offset:26112
    ds_read_b32 v76, v36 offset:26624
    ds_read_b32 v77, v36 offset:27136
    ds_read_b32 v78, v36 offset:27648
    ds_read_b32 v79, v36 offset:28160
    s_waitcnt lgkmcnt(0)
    v_add_f32 v48, v48, v49
    v_add_f32 v64, v64, v65
    v_add_f32 v48, v48, v50
    v_add_f32 v64, v64, v66
    v_add_f32 v48, v48, v51
    v_add_f32 v64, v64, v67
    v_add_f32 v48, v48, v52
    v_add_f32 v64, v64, v68
    v_add_f32 v48, v48, v53
    v_add_f32 v64, v64, v69
    v_add_f32 v48, v48, v54
    v_add_f32 v64, v64, v70
    v_add_f32 v48, v48, v55
    v_add_f32 v64, v64, v71
    v_add_f32 v48, v48, v56
    v_add_f32 v64, v64, v72
    v_add_f32 v48, v48, v57
    v_add_f32 v64, v64, v73
    v_add_f32 v48, v48, v58
    v_add_f32 v64, v64, v74
    v_add_f32 v48, v48, v59
    v_add_f32 v64, v64, v75
    v_add_f32 v48, v48, v60
    v_add_f32 v64, v64, v76
    v_add_f32 v48, v48, v61
    v_add_f32 v64, v64, v77
    v_add_f32 v48, v48, v62
    v_add_f32 v64, v64, v78
    v_add_f32 v48, v48, v63
    v_add_f32 v64, v64, v79
    v_rcp_f32 v40, v48
    s_nop 0
    v_mul_f32 v41, v64, v40
    v_fma_f32 v39, -v41, v48, v64
    v_fma_f32 v39, v39, v40, v41
    v_cvt_pk_bf16_f32 v39, v39, v39
    ds_write_b32 v36, v39 offset:29184
    s_waitcnt lgkmcnt(0)
L_c_skip:
    s_barrier
    s_lshl_b32 s8, s3, 3
    v_add_u32 v36, s8, v2
    v_lshlrev_b32 v36, 2, v36
    ds_read_b32 v37, v36 offset:29184
    ds_read_b32 v38, v36 offset:29200
    v_mov_b32 v48, 0
    v_mov_b32 v49, 0
    v_mov_b32 v50, 0
    v_mov_b32 v51, 0
    v_mov_b32 v52, 0
    v_mov_b32 v53, 0
    v_mov_b32 v54, 0
    v_mov_b32 v55, 0
    v_mov_b32 v56, 0
    v_mov_b32 v57, 0
    v_mov_b32 v58, 0
    v_mov_b32 v59, 0
    v_mov_b32 v60, 0
    v_mov_b32 v61, 0
    v_mov_b32 v62, 0
    v_mov_b32 v63, 0
    v_mov_b32 v64, 0
    v_mov_b32 v65, 0
    v_mov_b32 v66, 0
    v_mov_b32 v67, 0
    s_waitcnt lgkmcnt(0)
    v_and_b32 v28, v37, v4
    v_and_b32 v29, v37, v5
    v_and_b32 v30, v37, v6
    v_and_b32 v31, v37, v7
    v_and_b32 v32, v38, v4
    v_and_b32 v33, v38, v5
    v_and_b32 v34, v38, v6
    v_and_b32 v35, v38, v7
    s_waitcnt vmcnt(0)
    s_nop 0
    v_mfma_f32_16x16x32_bf16 v[48:51], v[28:31], v[80:83], v[48:51]
    v_mfma_f32_16x16x32_bf16 v[52:55], v[28:31], v[84:87], v[52:55]
    v_mfma_f32_16x16x32_bf16 v[56:59], v[28:31], v[88:91], v[56:59]
    v_mfma_f32_16x16x32_bf16 v[60:63], v[28:31], v[92:95], v[60:63]
    v_mfma_f32_16x16x32_bf16 v[64:67], v[28:31], v[96:99], v[64:67]
    v_mfma_f32_16x16x32_bf16 v[48:51], v[32:35], v[100:103], v[48:51]
    v_mfma_f32_16x16x32_bf16 v[52:55], v[32:35], v[104:107], v[52:55]
    v_mfma_f32_16x16x32_bf16 v[56:59], v[32:35], v[108:111], v[56:59]
    v_mfma_f32_16x16x32_bf16 v[60:63], v[32:35], v[112:115], v[60:63]
    v_mfma_f32_16x16x32_bf16 v[64:67], v[32:35], v[116:119], v[64:67]
    v_lshlrev_b32 v38, 5, v3
    v_lshl_add_u32 v38, v2, 4, v38
    s_mul_i32 s8, s3, 2560
    v_add_u32 v38, s8, v38
    s_nop 7
    s_mov_b32 exec_hi, 0
    ds_write_b128 v38, v[48:51] offset:32768
    ds_write_b128 v38, v[52:55] offset:33280
    ds_write_b128 v38, v[56:59] offset:33792
    ds_write_b128 v38, v[60:63] offset:34304
    ds_write_b128 v38, v[64:67] offset:34816
    s_mov_b64 exec, -1
    s_waitcnt lgkmcnt(0)
    s_barrier
    s_cmp_ge_u32 s3, 3
    s_cbranch_scc1 L_s_skip
    v_cmp_gt_u32 vcc, 160, v0
    s_and_saveexec_b64 s[12:13], vcc
    s_cbranch_execz L_s_skip2
    v_lshlrev_b32 v36, 4, v0
    v_add_u32 v37, 32768, v36
    ds_read_b128 v[48:51], v37 offset:0
    ds_read_b128 v[52:55], v37 offset:2560
    ds_read_b128 v[56:59], v37 offset:5120
    ds_read_b128 v[60:63], v37 offset:7680
    ds_read_b128 v[64:67], v37 offset:10240
    ds_read_b128 v[68:71], v37 offset:12800
    ds_read_b128 v[72:75], v37 offset:15360
    ds_read_b128 v[76:79], v37 offset:17920
    ds_read_b128 v[80:83], v37 offset:20480
    ds_read_b128 v[84:87], v37 offset:23040
    ds_read_b128 v[88:91], v37 offset:25600
    ds_read_b128 v[92:95], v37 offset:28160
    ds_read_b128 v[96:99], v37 offset:30720
    ds_read_b128 v[100:103], v37 offset:33280
    ds_read_b128 v[104:107], v37 offset:35840
    ds_read_b128 v[108:111], v37 offset:38400
    s_mul_i32 s8, s4, 151040
    s_mul_i32 s9, s5, 2560
    s_add_u32 s8, s8, s9
    v_add_u32 v36, s8, v36
    s_waitcnt lgkmcnt(0)
    v_add_f32 v48, v48, v52
    v_add_f32 v49, v49, v53
    v_add_f32 v50, v50, v54
    v_add_f32 v51, v51, v55
    v_add_f32 v48, v48, v56
    v_add_f32 v49, v49, v57
    v_add_f32 v50, v50, v58
    v_add_f32 v51, v51, v59
    v_add_f32 v48, v48, v60
    v_add_f32 v49, v49, v61
    v_add_f32 v50, v50, v62
    v_add_f32 v51, v51, v63
    v_add_f32 v48, v48, v64
    v_add_f32 v49, v49, v65
    v_add_f32 v50, v50, v66
    v_add_f32 v51, v51, v67
    v_add_f32 v48, v48, v68
    v_add_f32 v49, v49, v69
    v_add_f32 v50, v50, v70
    v_add_f32 v51, v51, v71
    v_add_f32 v48, v48, v72
    v_add_f32 v49, v49, v73
    v_add_f32 v50, v50, v74
    v_add_f32 v51, v51, v75
    v_add_f32 v48, v48, v76
    v_add_f32 v49, v49, v77
    v_add_f32 v50, v50, v78
    v_add_f32 v51, v51, v79
    v_add_f32 v48, v48, v80
    v_add_f32 v49, v49, v81
    v_add_f32 v50, v50, v82
    v_add_f32 v51, v51, v83
    v_add_f32 v48, v48, v84
    v_add_f32 v49, v49, v85
    v_add_f32 v50, v50, v86
    v_add_f32 v51, v51, v87
    v_add_f32 v48, v48, v88
    v_add_f32 v49, v49, v89
    v_add_f32 v50, v50, v90
    v_add_f32 v51, v51, v91
    v_add_f32 v48, v48, v92
    v_add_f32 v49, v49, v93
    v_add_f32 v50, v50, v94
    v_add_f32 v51, v51, v95
    v_add_f32 v48, v48, v96
    v_add_f32 v49, v49, v97
    v_add_f32 v50, v50, v98
    v_add_f32 v51, v51, v99
    v_add_f32 v48, v48, v100
    v_add_f32 v49, v49, v101
    v_add_f32 v50, v50, v102
    v_add_f32 v51, v51, v103
    v_add_f32 v48, v48, v104
    v_add_f32 v49, v49, v105
    v_add_f32 v50, v50, v106
    v_add_f32 v51, v51, v107
    v_add_f32 v48, v48, v108
    v_add_f32 v49, v49, v109
    v_add_f32 v50, v50, v110
    v_add_f32 v51, v51, v111
    global_store_dwordx4 v36, v[48:51], s[40:41] sc1
    s_waitcnt vmcnt(0)
L_s_skip2:
    s_mov_b64 exec, s[12:13]
L_s_skip:
    s_barrier
    s_cmp_lg_u32 s3, 0
    s_cbranch_scc1 L_sig_done
    s_mov_b64 exec, 1
    s_lshl_b32 s8, s4, 2
    v_mov_b32 v36, s8
    v_mov_b32 v37, 1
    global_atomic_add v38, v36, v37, s[38:39] sc0
    s_waitcnt vmcnt(0)
    v_readfirstlane_b32 s8, v38
    s_lshl_b32 s9, 1, s4
    s_cmp_eq_u32 s8, 58
    s_cselect_b32 s9, s9, 0
    v_mov_b32 v36, 0
    v_mov_b32 v37, s9
    ds_or_b32 v36, v37 offset:29056
    s_waitcnt lgkmcnt(0)
    s_mov_b64 exec, -1
L_sig_done:
    s_barrier
    v_mov_b32 v36, 0
    ds_read_b32 v37, v36 offset:29056
    s_waitcnt lgkmcnt(0)
    v_readfirstlane_b32 s7, v37
    s_cmp_eq_u32 s7, 0
    s_cbranch_scc1 L_end2
L_fin_loop:
    s_ff1_i32_b32 s14, s7
    s_lshl_b32 s8, 1, s14
    s_xor_b32 s7, s7, s8
    s_mul_i32 s8, s14, 151040
    s_add_u32 s10, s40, s8
    s_addc_u32 s11, s41, 0
    s_mov_b32 s72, s10
    s_and_b32 s73, s11, 0xffff
    s_mov_b32 s74, 151040
    s_mov_b32 s75, 0x00020000
    v_mul_u32_u24 v36, 52429, v0
    v_lshrrev_b32 v36, 23, v36
    v_mul_u32_u24 v37, 160, v36
    v_sub_u32 v37, v0, v37
    v_lshlrev_b32 v37, 4, v37
    s_movk_i32 s9, 2560
    v_mul_lo_u32 v38, v36, s9
    v_add_u32 v38, v38, v37
    v_cmp_gt_u32 vcc, 960, v0
    s_and_saveexec_b64 s[12:13], vcc
    s_cbranch_execz L_fin_a
    s_mov_b32 s6, 0
    buffer_load_dwordx4 v[48:51], v38, s[72:75], s6 offen sc1
    s_mov_b32 s6, 15360
    buffer_load_dwordx4 v[52:55], v38, s[72:75], s6 offen sc1
    s_mov_b32 s6, 30720
    buffer_load_dwordx4 v[56:59], v38, s[72:75], s6 offen sc1
    s_mov_b32 s6, 46080
    buffer_load_dwordx4 v[60:63], v38, s[72:75], s6 offen sc1
    s_mov_b32 s6, 61440
    buffer_load_dwordx4 v[64:67], v38, s[72:75], s6 offen sc1
    s_mov_b32 s6, 76800
    buffer_load_dwordx4 v[68:71], v38, s[72:75], s6 offen sc1
    s_mov_b32 s6, 92160
    buffer_load_dwordx4 v[72:75], v38, s[72:75], s6 offen sc1
    s_mov_b32 s6, 107520
    buffer_load_dwordx4 v[76:79], v38, s[72:75], s6 offen sc1
    s_mov_b32 s6, 122880
    buffer_load_dwordx4 v[80:83], v38, s[72:75], s6 offen sc1
    s_mov_b32 s6, 138240
    buffer_load_dwordx4 v[84:87], v38, s[72:75], s6 offen sc1
    v_cmp_gt_u32 vcc, 2, v36
    s_waitcnt vmcnt(0)
    v_add_f32 v48, v48, v52
    v_add_f32 v49, v49, v53
    v_add_f32 v50, v50, v54
    v_add_f32 v51, v51, v55
    v_add_f32 v48, v48, v56
    v_add_f32 v49, v49, v57
    v_add_f32 v50, v50, v58
    v_add_f32 v51, v51, v59
    v_add_f32 v48, v48, v60
    v_add_f32 v49, v49, v61
    v_add_f32 v50, v50, v62
    v_add_f32 v51, v51, v63
    v_add_f32 v48, v48, v64
    v_add_f32 v49, v49, v65
    v_add_f32 v50, v50, v66
    v_add_f32 v51, v51, v67
    v_add_f32 v72, v72, v76
    v_add_f32 v73, v73, v77
    v_add_f32 v74, v74, v78
    v_add_f32 v75, v75, v79
    v_add_f32 v72, v72, v80
    v_add_f32 v73, v73, v81
    v_add_f32 v74, v74, v82
    v_add_f32 v75, v75, v83
    v_add_f32 v72, v72, v84
    v_add_f32 v73, v73, v85
    v_add_f32 v74, v74, v86
    v_add_f32 v75, v75, v87
    v_cndmask_b32 v40, 0, v68, vcc
    v_cndmask_b32 v41, v68, 0, vcc
    v_add_f32 v48, v48, v40
    v_add_f32 v72, v72, v41
    v_cndmask_b32 v40, 0, v69, vcc
    v_cndmask_b32 v41, v69, 0, vcc
    v_add_f32 v49, v49, v40
    v_add_f32 v73, v73, v41
    v_cndmask_b32 v40, 0, v70, vcc
    v_cndmask_b32 v41, v70, 0, vcc
    v_add_f32 v50, v50, v40
    v_add_f32 v74, v74, v41
    v_cndmask_b32 v40, 0, v71, vcc
    v_cndmask_b32 v41, v71, 0, vcc
    v_add_f32 v51, v51, v40
    v_add_f32 v75, v75, v41
    s_movk_i32 s9, 5120
    v_mul_lo_u32 v38, v36, s9
    v_add_u32 v38, v38, v37
    ds_write_b128 v38, v[48:51] offset:32768
    ds_write_b128 v38, v[72:75] offset:35328
    s_waitcnt lgkmcnt(0)
L_fin_a:
    s_mov_b64 exec, s[12:13]
    s_barrier
    v_cmp_gt_u32 vcc, 640, v0
    s_and_saveexec_b64 s[12:13], vcc
    s_cbranch_execz L_fin_b
    v_lshlrev_b32 v36, 2, v0
    ds_read_b32 v48, v36 offset:32768
    ds_read_b32 v56, v36 offset:35328
    ds_read_b32 v49, v36 offset:37888
    ds_read_b32 v57, v36 offset:40448
    ds_read_b32 v50, v36 offset:43008
    ds_read_b32 v58, v36 offset:45568
    ds_read_b32 v51, v36 offset:48128
    ds_read_b32 v59, v36 offset:50688
    ds_read_b32 v52, v36 offset:53248
    ds_read_b32 v60, v36 offset:55808
    ds_read_b32 v53, v36 offset:58368
    ds_read_b32 v61, v36 offset:60928
    v_lshlrev_b32 v37, 1, v0
    global_load_ushort v38, v37, s[34:35]
    s_mul_i32 s8, s14, 1280
    v_add_u32 v37, s8, v37
    global_load_ushort v39, v37, s[16:17]
    s_waitcnt lgkmcnt(0)
    v_add_f32 v48, v48, v49
    v_add_f32 v56, v56, v57
    v_add_f32 v48, v48, v50
    v_add_f32 v56, v56, v58
    v_add_f32 v48, v48, v51
    v_add_f32 v56, v56, v59
    v_add_f32 v48, v48, v52
    v_add_f32 v56, v56, v60
    v_add_f32 v48, v48, v53
    v_add_f32 v56, v56, v61
    v_cvt_pk_bf16_f32 v48, v48, v48
    v_and_b32 v48, 0xffff0000, v48
    v_cvt_pk_bf16_f32 v56, v56, v56
    v_and_b32 v56, 0xffff0000, v56
    s_waitcnt vmcnt(0)
    v_lshlrev_b32 v38, 16, v38
    v_lshlrev_b32 v39, 16, v39
    v_add_f32 v56, v56, v38
    v_cvt_pk_bf16_f32 v56, v56, v56
    v_and_b32 v56, 0xffff0000, v56
    v_mul_f32 v40, 0xbfb8aa3b, v56
    v_exp_f32 v40, v40
    s_nop 0
    v_add_f32 v40, 1.0, v40
    v_rcp_f32 v40, v40
    s_nop 0
    v_mul_f32 v56, v56, v40
    v_cvt_pk_bf16_f32 v56, v56, v56
    v_and_b32 v56, 0xffff0000, v56
    v_mul_f32 v48, v48, v56
    v_cvt_pk_bf16_f32 v48, v48, v48
    v_and_b32 v48, 0xffff0000, v48
    v_add_f32 v48, v48, v39
    v_cvt_pk_bf16_f32 v48, v48, v48
    global_store_short v37, v48, s[36:37]
    s_waitcnt vmcnt(0)
L_fin_b:
    s_mov_b64 exec, s[12:13]
    s_barrier
    s_cmp_lg_u32 s7, 0
    s_cbranch_scc1 L_fin_loop
L_end2:
L_end:
    s_endpgm
.section .rodata,"a"
.p2align 6
.amdhsa_kernel recurrent_scan__mha_block_cached__dense_activation_gelu__decode_kernel
  .amdhsa_next_free_vgpr 128
  .amdhsa_next_free_sgpr 102
  .amdhsa_accum_offset 128
  .amdhsa_group_segment_fixed_size 0
  .amdhsa_kernarg_size 104
  .amdhsa_user_sgpr_count 2
  .amdhsa_user_sgpr_kernarg_segment_ptr 1
  .amdhsa_system_sgpr_workgroup_id_x 1
.end_amdhsa_kernel
```
